```python
import torch

def _softmax(x, axis=-1):
    return torch.softmax(x, dim=axis)
def _gelu(x):
    return torch.nn.functional.gelu(x, approximate="tanh")
def _silu(x):
    return torch.nn.functional.silu(x)
def _sigmoid(x):
    return torch.sigmoid(x)
def _layernorm(x, axis=-1, eps=1e-5):
    m = x.mean(dim=axis, keepdim=True)
    v = x.var(dim=axis, keepdim=True, unbiased=False)
    return (x - m) / torch.sqrt(v + eps)
def _scatter_add(tgt, idx, src, axis=0):
    return tgt.clone().index_add_(axis, idx, src)
def _segment_sum(src, seg, n):
    out = torch.zeros((n,) + src.shape[1:], dtype=src.dtype)
    return out.index_add_(0, seg, src)
def _pad(x, pw):
    flat = tuple(v for pair in reversed(pw) for v in pair)
    return torch.nn.functional.pad(x, flat)

kernel_name = 'concat_heads__gqa_block_cached__gqa_block_cached__decode'

def setup_inputs():

    _w = (lambda a: (lambda t: t.to(torch.bfloat16) if t.is_floating_point() else t)(torch.as_tensor(a)))
    def _A_setup():
        B, Sq, D = 1, 1, 576
        Hq, Hkv, Sk, Dh = 32, 16, 16384, 128
        assert Hq % Hkv == 0, (Hq, Hkv)
        return {
            "x": _w((lambda *s: torch.randn(*s, dtype=torch.bfloat16) * 0.8)(B, Sq, D)),
            "k_cache": _w((lambda *s: torch.randn(*s, dtype=torch.bfloat16) * 0.8)(B, Hkv, Sk, Dh)),
            "v_cache": _w((lambda *s: torch.randn(*s, dtype=torch.bfloat16) * 0.05)(B, Hkv, Sk, Dh)),
            "wq": _w((lambda *s: torch.randn(*s, dtype=torch.bfloat16) * 0.8)(D, Hq * Dh) * (D ** -0.5)),
            "wo": _w((lambda *s: torch.randn(*s, dtype=torch.bfloat16) * 0.05)(Hq * Dh, D) * ((Hq * Dh) ** -0.5)),
        }
    _A_in = _A_setup()

    def _B_setup():
        B, Sq, D = 1, 1, 576
        Hq, Hkv, Sk, Dh = 32, 16, 16384, 128
        assert Hq % Hkv == 0, (Hq, Hkv)
        return {
            "x": _w((lambda *s: torch.randn(*s, dtype=torch.bfloat16) * 0.8)(B, Sq, D)),
            "k_cache": _w((lambda *s: torch.randn(*s, dtype=torch.bfloat16) * 0.8)(B, Hkv, Sk, Dh)),
            "v_cache": _w((lambda *s: torch.randn(*s, dtype=torch.bfloat16) * 0.05)(B, Hkv, Sk, Dh)),
            "wq": _w((lambda *s: torch.randn(*s, dtype=torch.bfloat16) * 0.8)(D, Hq * Dh) * (D ** -0.5)),
            "wo": _w((lambda *s: torch.randn(*s, dtype=torch.bfloat16) * 0.05)(Hq * Dh, D) * ((Hq * Dh) ** -0.5)),
        }
    _B_in = _B_setup()

    return {
        "A_x": _A_in["x"],
        "A_k_cache": _A_in["k_cache"],
        "A_v_cache": _A_in["v_cache"],
        "A_wq": _A_in["wq"],
        "A_wo": _A_in["wo"],
        "B_x": _B_in["x"],
        "B_k_cache": _B_in["k_cache"],
        "B_v_cache": _B_in["v_cache"],
        "B_wq": _B_in["wq"],
        "B_wo": _B_in["wo"],
    }

def reference(A_x, A_k_cache, A_v_cache, A_wq, A_wo, B_x, B_k_cache, B_v_cache, B_wq, B_wo):
    def _A_ref(x, k_cache, v_cache, wq, wo):
        B, Sq, D = x.shape
        Hq, Dh = 32, 128
        Hkv = k_cache.shape[1]
        rep = Hq // Hkv
        q = (lambda x, *d: x.permute(*d))((x @ wq).reshape(B, Sq, Hq, Dh), 0, 2, 1, 3)
        k = (lambda x, n, axis: torch.repeat_interleave(x, n, dim=axis))(k_cache, rep, axis=1)
        v = (lambda x, n, axis: torch.repeat_interleave(x, n, dim=axis))(v_cache, rep, axis=1)
        scores = torch.einsum("bhqd,bhkd->bhqk", q, k) * (Dh ** -0.5)
        p = _softmax(scores, axis=-1)
        o = torch.einsum("bhqk,bhkd->bhqd", p, v)
        return (lambda x, *d: x.permute(*d))(o, 0, 2, 1, 3).reshape(B, Sq, Hq * Dh) @ wo

    def _B_ref(x, k_cache, v_cache, wq, wo):
        B, Sq, D = x.shape
        Hq, Dh = 32, 128
        Hkv = k_cache.shape[1]
        rep = Hq // Hkv
        q = (lambda x, *d: x.permute(*d))((x @ wq).reshape(B, Sq, Hq, Dh), 0, 2, 1, 3)
        k = (lambda x, n, axis: torch.repeat_interleave(x, n, dim=axis))(k_cache, rep, axis=1)
        v = (lambda x, n, axis: torch.repeat_interleave(x, n, dim=axis))(v_cache, rep, axis=1)
        scores = torch.einsum("bhqd,bhkd->bhqk", q, k) * (Dh ** -0.5)
        p = _softmax(scores, axis=-1)
        o = torch.einsum("bhqk,bhkd->bhqd", p, v)
        return (lambda x, *d: x.permute(*d))(o, 0, 2, 1, 3).reshape(B, Sq, Hq * Dh) @ wo

    a = _A_ref(A_x, A_k_cache, A_v_cache, A_wq, A_wo)
    b = _B_ref(B_x, B_k_cache, B_v_cache, B_wq, B_wo)
    return torch.concatenate([a, b], axis=-1)
```

```asm
; @launch grid=(256,1,1) block=(1024,1,1) lds=35856
.amdgcn_target "amdgcn-amd-amdhsa--gfx950"
.text
.globl concat_heads__gqa_block_cached__gqa_block_cached__decode_kernel
.p2align 8
.type concat_heads__gqa_block_cached__gqa_block_cached__decode_kernel,@function
concat_heads__gqa_block_cached__gqa_block_cached__decode_kernel:
    s_cmp_ge_u32 s2, 256
    s_cbranch_scc1 L_end
    s_load_dwordx16 s[16:31], s[0:1], 0
    s_load_dwordx8 s[32:39], s[0:1], 64
    s_load_dwordx2 s[40:41], s[0:1], 96
    v_and_b32 v1, 63, v0
    v_lshrrev_b32 v5, 6, v0
    s_and_b32 s8, s2, 31
    v_readfirstlane_b32 s3, v5
    s_and_b32 s5, s8, 15
    s_lshr_b32 s4, s8, 4
    s_lshr_b32 s6, s2, 5
    s_lshl_b32 s7, s6, 4
    s_add_u32 s7, s7, s5
    s_lshl_b32 s11, s5, 3
    s_add_u32 s11, s11, s6
    s_mov_b32 s90, 0x05040100
    s_mov_b32 s91, 0x07060302
    s_mov_b32 s92, 3456
    s_mov_b32 s93, 6912
    s_mov_b32 s94, 0x3db504f3
    s_mov_b32 s95, 0x3fb8aa3b
    s_mov_b32 s97, 0xffff0000
    s_mul_i32 s76, s3, 1040
    s_mul_i32 s12, s3, 2048
    v_lshrrev_b32 v5, 3, v1
    v_lshlrev_b32 v5, 8, v5
    v_and_b32 v6, 7, v1
    v_lshl_add_u32 v2, v6, 4, v5
    v_add_u32 v2, s12, v2
    v_lshrrev_b32 v5, 4, v1
    v_lshlrev_b32 v5, 9, v5
    v_and_b32 v6, 15, v1
    v_lshl_add_u32 v3, v6, 4, v5
    v_add_u32 v3, s12, v3
    v_and_b32 v5, 15, v1
    s_lshl_b32 s12, s3, 4
    v_add_u32 v5, s12, v5
    v_lshrrev_b32 v7, 3, v5
    v_lshlrev_b32 v7, 14, v7
    v_and_b32 v5, 7, v5
    v_lshl_add_u32 v7, v5, 4, v7
    s_mul_i32 s12, s4, 294912
    s_lshl_b32 s13, s11, 7
    s_add_u32 s12, s12, s13
    s_add_u32 s12, s12, 299008
    v_add_u32 v124, s12, v7
    s_lshl_b32 s12, s8, 3
    s_add_u32 s12, s12, s6
    s_lshl_b32 s12, s12, 10
    s_lshl_b32 s13, s3, 6
    s_add_u32 s12, s12, s13
    s_add_u32 s12, s12, 36864
    v_and_b32 v5, 3, v1
    v_lshl_add_u32 v127, v5, 4, s12
    s_lshl_b32 s12, s4, 7
    s_add_u32 s12, s12, s11
    s_lshl_b32 s12, s12, 4
    s_cmp_lt_u32 s3, 9
    s_cbranch_scc1 L_ya_ok
    v_mov_b32 v124, s12
L_ya_ok:
    v_mov_b32 v56, -1
    v_mov_b32 v57, -1
    v_mov_b32 v58, -1
    v_mov_b32 v59, -1
    s_lshl_b32 s12, s5, 22
    s_lshl_b32 s13, s6, 19
    s_add_u32 s12, s12, s13
    s_waitcnt lgkmcnt(0)
    s_cmp_eq_u32 s4, 1
    s_cselect_b32 s80, s26, s16
    s_cselect_b32 s81, s27, s17
    s_cselect_b32 s44, s28, s18
    s_cselect_b32 s45, s29, s19
    s_cselect_b32 s48, s30, s20
    s_cselect_b32 s49, s31, s21
    s_cselect_b32 s52, s32, s22
    s_cselect_b32 s53, s33, s23
    s_cselect_b32 s56, s34, s24
    s_cselect_b32 s57, s35, s25
    s_add_u32 s44, s44, s12
    s_addc_u32 s45, s45, 0
    s_add_u32 s48, s48, s12
    s_addc_u32 s49, s49, 0
    s_and_b32 s81, s81, 0xffff
    s_mov_b32 s82, 1152
    s_mov_b32 s83, 0x00020000
    s_and_b32 s45, s45, 0xffff
    s_mov_b32 s46, 524288
    s_mov_b32 s47, 0x00020000
    s_and_b32 s49, s49, 0xffff
    s_mov_b32 s50, 524288
    s_mov_b32 s51, 0x00020000
    s_and_b32 s53, s53, 0xffff
    s_mov_b32 s54, 4718592
    s_mov_b32 s55, 0x00020000
    s_and_b32 s57, s57, 0xffff
    s_mov_b32 s58, 4718592
    s_mov_b32 s59, 0x00020000
    s_mov_b32 s60, s40
    s_and_b32 s61, s41, 0xffff
    s_mov_b32 s62, 888832
    s_mov_b32 s63, 0x00020000
    s_mov_b32 s64, s38
    s_and_b32 s65, s39, 0xffff
    s_mov_b32 s66, 256
    s_mov_b32 s67, 0x00020000
    s_mov_b32 s68, s36
    s_and_b32 s69, s37, 0xffff
    s_mov_b32 s70, 2304
    s_mov_b32 s71, 0x00020000
    s_cmp_ge_u32 s3, 12
    s_cbranch_scc1 L_nowq
    s_cmp_ge_u32 s6, 4
    s_cbranch_scc1 L_wqdone
    s_mul_i32 s12, s3, 48
    v_lshrrev_b32 v5, 3, v1
    v_add_u32 v5, s12, v5
    v_lshlrev_b32 v6, 1, v5
    v_lshlrev_b32 v5, 13, v5
    v_and_b32 v7, 7, v1
    v_lshl_add_u32 v5, v7, 4, v5
    s_lshl_b32 s12, s5, 9
    s_lshl_b32 s13, s6, 7
    s_add_u32 s12, s12, s13
    buffer_load_dwordx4 v[64:67], v5, s[52:55], s12 offen nt
    s_add_u32 s12, s12, 65536
    buffer_load_dwordx4 v[68:71], v5, s[52:55], s12 offen nt
    s_add_u32 s12, s12, 65536
    buffer_load_dwordx4 v[72:75], v5, s[52:55], s12 offen nt
    s_add_u32 s12, s12, 65536
    buffer_load_dwordx4 v[76:79], v5, s[52:55], s12 offen nt
    s_add_u32 s12, s12, 65536
    buffer_load_dwordx4 v[80:83], v5, s[52:55], s12 offen nt
    s_add_u32 s12, s12, 65536
    buffer_load_dwordx4 v[84:87], v5, s[52:55], s12 offen nt
    buffer_load_ushort v88, v6, s[80:83], 0 offen offset:0
    buffer_load_ushort v89, v6, s[80:83], 0 offen offset:16
    buffer_load_ushort v90, v6, s[80:83], 0 offen offset:32
    buffer_load_ushort v91, v6, s[80:83], 0 offen offset:48
    buffer_load_ushort v92, v6, s[80:83], 0 offen offset:64
    buffer_load_ushort v93, v6, s[80:83], 0 offen offset:80
    s_branch L_wqdone
L_nowq:
    s_cmp_lg_u32 s3, 15
    s_cbranch_scc1 L_wqdone
    s_memrealtime s[98:99]
    s_lshl_b32 s12, s8, 2
    v_mov_b32 v5, s12
    v_mov_b32 v65, 0
    s_waitcnt lgkmcnt(0)
    s_or_b32 s72, s98, 1
    v_mov_b32 v64, s72
    s_mov_b64 exec, 1
    buffer_atomic_cmpswap v[64:65], v5, s[64:67], 0 offen offset:64 sc0 sc1
    s_mov_b64 exec, -1
L_wqdone:
    s_mov_b64 exec, 0xf
    buffer_store_dwordx4 v[56:59], v127, s[60:63], 0 offen sc1
    s_mov_b64 exec, -1
    s_cmp_ge_u32 s3, 10
    s_cbranch_scc1 L_nosent
    s_mov_b64 exec, 0xffff
    buffer_store_dwordx4 v[56:59], v124, s[60:63], 0 offen sc1
    s_mov_b64 exec, -1
L_nosent:
    s_barrier
    s_mov_b32 s9, 0
    s_cmp_ge_u32 s3, 14
    s_cbranch_scc1 L_nokpre
    buffer_load_dwordx4 v[8:11], v2, s[44:47], s9 offen nt
    buffer_load_dwordx4 v[12:15], v2, s[44:47], s9 offen offset:128 nt
    s_add_u32 s9, s9, 32768
    buffer_load_dwordx4 v[16:19], v2, s[44:47], s9 offen nt
    buffer_load_dwordx4 v[20:23], v2, s[44:47], s9 offen offset:128 nt
    s_add_u32 s9, s9, 32768
L_nokpre:
    s_lshl_b32 s12, s5, 8
    s_lshl_b32 s13, s6, 5
    s_add_u32 s12, s12, s13
    s_and_b32 s13, s3, 7
    s_lshl_b32 s13, s13, 2
    s_add_u32 s12, s12, s13
    s_mul_i32 s12, s12, 1152
    v_lshrrev_b32 v5, 5, v1
    v_mul_u32_u24 v5, 2304, v5
    v_add_u32 v5, s12, v5
    v_and_b32 v7, 31, v1
    v_lshl_add_u32 v126, v7, 4, v5
    v_lshl_add_u32 v125, v7, 2, v5
    s_waitcnt vmcnt(4)
    s_cmp_lt_u32 s3, 14
    s_cbranch_scc1 L_nonon
    s_waitcnt vmcnt(0)
    s_cmp_lg_u32 s3, 15
    s_cbranch_scc1 L_nonon
    v_readfirstlane_b32 s14, v64
    s_nop 3
    s_cmp_eq_u32 s14, 0
    s_cselect_b32 s72, s72, s14
    v_mov_b32 v5, 17408
    v_mov_b32 v6, s72
    ds_write_b32 v5, v6
    s_waitcnt lgkmcnt(0)
L_nonon:
    s_cmp_ge_u32 s3, 12
    s_cbranch_scc1 L_noq1
    s_cmp_ge_u32 s6, 4
    s_cbranch_scc1 L_noq1
    v_lshlrev_b32 v88, 16, v88
    v_lshlrev_b32 v89, 16, v89
    v_lshlrev_b32 v90, 16, v90
    v_lshlrev_b32 v91, 16, v91
    v_lshlrev_b32 v92, 16, v92
    v_lshlrev_b32 v93, 16, v93
    v_lshlrev_b32 v56, 16, v64
    v_and_b32 v57, s97, v64
    v_lshlrev_b32 v58, 16, v65
    v_and_b32 v59, s97, v65
    v_lshlrev_b32 v60, 16, v66
    v_and_b32 v61, s97, v66
    v_lshlrev_b32 v62, 16, v67
    v_and_b32 v63, s97, v67
    v_mul_f32 v40, v56, v88
    v_mul_f32 v41, v57, v88
    v_mul_f32 v42, v58, v88
    v_mul_f32 v43, v59, v88
    v_mul_f32 v44, v60, v88
    v_mul_f32 v45, v61, v88
    v_mul_f32 v46, v62, v88
    v_mul_f32 v47, v63, v88
    v_lshlrev_b32 v56, 16, v68
    v_and_b32 v57, s97, v68
    v_lshlrev_b32 v58, 16, v69
    v_and_b32 v59, s97, v69
    v_lshlrev_b32 v60, 16, v70
    v_and_b32 v61, s97, v70
    v_lshlrev_b32 v62, 16, v71
    v_and_b32 v63, s97, v71
    v_fmac_f32 v40, v56, v89
    v_fmac_f32 v41, v57, v89
    v_fmac_f32 v42, v58, v89
    v_fmac_f32 v43, v59, v89
    v_fmac_f32 v44, v60, v89
    v_fmac_f32 v45, v61, v89
    v_fmac_f32 v46, v62, v89
    v_fmac_f32 v47, v63, v89
    v_lshlrev_b32 v56, 16, v72
    v_and_b32 v57, s97, v72
    v_lshlrev_b32 v58, 16, v73
    v_and_b32 v59, s97, v73
    v_lshlrev_b32 v60, 16, v74
    v_and_b32 v61, s97, v74
    v_lshlrev_b32 v62, 16, v75
    v_and_b32 v63, s97, v75
    v_fmac_f32 v40, v56, v90
    v_fmac_f32 v41, v57, v90
    v_fmac_f32 v42, v58, v90
    v_fmac_f32 v43, v59, v90
    v_fmac_f32 v44, v60, v90
    v_fmac_f32 v45, v61, v90
    v_fmac_f32 v46, v62, v90
    v_fmac_f32 v47, v63, v90
    v_lshlrev_b32 v56, 16, v76
    v_and_b32 v57, s97, v76
    v_lshlrev_b32 v58, 16, v77
    v_and_b32 v59, s97, v77
    v_lshlrev_b32 v60, 16, v78
    v_and_b32 v61, s97, v78
    v_lshlrev_b32 v62, 16, v79
    v_and_b32 v63, s97, v79
    v_fmac_f32 v40, v56, v91
    v_fmac_f32 v41, v57, v91
    v_fmac_f32 v42, v58, v91
    v_fmac_f32 v43, v59, v91
    v_fmac_f32 v44, v60, v91
    v_fmac_f32 v45, v61, v91
    v_fmac_f32 v46, v62, v91
    v_fmac_f32 v47, v63, v91
    v_lshlrev_b32 v56, 16, v80
    v_and_b32 v57, s97, v80
    v_lshlrev_b32 v58, 16, v81
    v_and_b32 v59, s97, v81
    v_lshlrev_b32 v60, 16, v82
    v_and_b32 v61, s97, v82
    v_lshlrev_b32 v62, 16, v83
    v_and_b32 v63, s97, v83
    v_fmac_f32 v40, v56, v92
    v_fmac_f32 v41, v57, v92
    v_fmac_f32 v42, v58, v92
    v_fmac_f32 v43, v59, v92
    v_fmac_f32 v44, v60, v92
    v_fmac_f32 v45, v61, v92
    v_fmac_f32 v46, v62, v92
    v_fmac_f32 v47, v63, v92
    v_lshlrev_b32 v56, 16, v84
    v_and_b32 v57, s97, v84
    v_lshlrev_b32 v58, 16, v85
    v_and_b32 v59, s97, v85
    v_lshlrev_b32 v60, 16, v86
    v_and_b32 v61, s97, v86
    v_lshlrev_b32 v62, 16, v87
    v_and_b32 v63, s97, v87
    v_fmac_f32 v40, v56, v93
    v_fmac_f32 v41, v57, v93
    v_fmac_f32 v42, v58, v93
    v_fmac_f32 v43, v59, v93
    v_fmac_f32 v44, v60, v93
    v_fmac_f32 v45, v61, v93
    v_fmac_f32 v46, v62, v93
    v_fmac_f32 v47, v63, v93
    s_nop 1
    v_add_f32_dpp v40, v40, v40 row_ror:8 row_mask:0xf bank_mask:0xf
    v_add_f32_dpp v41, v41, v41 row_ror:8 row_mask:0xf bank_mask:0xf
    v_add_f32_dpp v42, v42, v42 row_ror:8 row_mask:0xf bank_mask:0xf
    v_add_f32_dpp v43, v43, v43 row_ror:8 row_mask:0xf bank_mask:0xf
    v_add_f32_dpp v44, v44, v44 row_ror:8 row_mask:0xf bank_mask:0xf
    v_add_f32_dpp v45, v45, v45 row_ror:8 row_mask:0xf bank_mask:0xf
    v_add_f32_dpp v46, v46, v46 row_ror:8 row_mask:0xf bank_mask:0xf
    v_add_f32_dpp v47, v47, v47 row_ror:8 row_mask:0xf bank_mask:0xf
    v_mov_b32 v48, v40
    v_mov_b32 v49, v41
    v_mov_b32 v50, v42
    v_mov_b32 v51, v43
    v_mov_b32 v52, v44
    v_mov_b32 v53, v45
    v_mov_b32 v54, v46
    v_mov_b32 v55, v47
    s_nop 1
    v_permlane16_swap_b32 v40, v48
    v_permlane16_swap_b32 v41, v49
    v_permlane16_swap_b32 v42, v50
    v_permlane16_swap_b32 v43, v51
    v_permlane16_swap_b32 v44, v52
    v_permlane16_swap_b32 v45, v53
    v_permlane16_swap_b32 v46, v54
    v_permlane16_swap_b32 v47, v55
    s_nop 1
    v_add_f32 v40, v40, v48
    v_add_f32 v41, v41, v49
    v_add_f32 v42, v42, v50
    v_add_f32 v43, v43, v51
    v_add_f32 v44, v44, v52
    v_add_f32 v45, v45, v53
    v_add_f32 v46, v46, v54
    v_add_f32 v47, v47, v55
    v_mov_b32 v48, v40
    v_mov_b32 v49, v41
    v_mov_b32 v50, v42
    v_mov_b32 v51, v43
    v_mov_b32 v52, v44
    v_mov_b32 v53, v45
    v_mov_b32 v54, v46
    v_mov_b32 v55, v47
    s_nop 1
    v_permlane32_swap_b32 v40, v48
    v_permlane32_swap_b32 v41, v49
    v_permlane32_swap_b32 v42, v50
    v_permlane32_swap_b32 v43, v51
    v_permlane32_swap_b32 v44, v52
    v_permlane32_swap_b32 v45, v53
    v_permlane32_swap_b32 v46, v54
    v_permlane32_swap_b32 v47, v55
    s_nop 1
    v_add_f32 v40, v40, v48
    v_add_f32 v41, v41, v49
    v_add_f32 v42, v42, v50
    v_add_f32 v43, v43, v51
    v_add_f32 v44, v44, v52
    v_add_f32 v45, v45, v53
    v_add_f32 v46, v46, v54
    v_add_f32 v47, v47, v55
    s_lshl_b32 s12, s3, 8
    v_lshl_add_u32 v5, v1, 5, s12
    s_mov_b64 exec, 0xff
    ds_write_b128 v5, v[40:43] offset:17424
    ds_write_b128 v5, v[44:47] offset:17440
    s_mov_b64 exec, -1
    s_waitcnt lgkmcnt(0)
L_noq1:
    s_barrier
    s_cmp_lt_u32 s3, 14
    s_cbranch_scc1 L_q2other
    s_cmp_eq_u32 s3, 14
    s_cbranch_scc1 L_q2poll
    s_cmp_ge_u32 s6, 4
    s_cbranch_scc1 L_nopub
    v_and_b32 v5, 15, v1
    v_lshlrev_b32 v5, 4, v5
    ds_read_b128 v[68:71], v5 offset:17424
    ds_read_b128 v[72:75], v5 offset:17680
    ds_read_b128 v[76:79], v5 offset:17936
    ds_read_b128 v[80:83], v5 offset:18192
    ds_read_b128 v[84:87], v5 offset:18448
    ds_read_b128 v[88:91], v5 offset:18704
    ds_read_b128 v[92:95], v5 offset:18960
    ds_read_b128 v[96:99], v5 offset:19216
    ds_read_b128 v[100:103], v5 offset:19472
    ds_read_b128 v[104:107], v5 offset:19728
    ds_read_b128 v[108:111], v5 offset:19984
    ds_read_b128 v[112:115], v5 offset:20240
    s_lshl_b32 s12, s8, 10
    s_add_u32 s12, s12, 4096
    s_lshl_b32 s13, s6, 8
    s_add_u32 s12, s12, s13
    v_add_u32 v5, s12, v5
    v_mov_b32 v57, s72
    v_mov_b32 v59, s72
    s_waitcnt lgkmcnt(0)
    v_add_f32 v68, v68, v92
    v_add_f32 v69, v69, v93
    v_add_f32 v70, v70, v94
    v_add_f32 v71, v71, v95
    v_add_f32 v72, v72, v96
    v_add_f32 v73, v73, v97
    v_add_f32 v74, v74, v98
    v_add_f32 v75, v75, v99
    v_add_f32 v76, v76, v100
    v_add_f32 v77, v77, v101
    v_add_f32 v78, v78, v102
    v_add_f32 v79, v79, v103
    v_add_f32 v80, v80, v104
    v_add_f32 v81, v81, v105
    v_add_f32 v82, v82, v106
    v_add_f32 v83, v83, v107
    v_add_f32 v84, v84, v108
    v_add_f32 v85, v85, v109
    v_add_f32 v86, v86, v110
    v_add_f32 v87, v87, v111
    v_add_f32 v88, v88, v112
    v_add_f32 v89, v89, v113
    v_add_f32 v90, v90, v114
    v_add_f32 v91, v91, v115
    v_add_f32 v68, v68, v80
    v_add_f32 v69, v69, v81
    v_add_f32 v70, v70, v82
    v_add_f32 v71, v71, v83
    v_add_f32 v72, v72, v84
    v_add_f32 v73, v73, v85
    v_add_f32 v74, v74, v86
    v_add_f32 v75, v75, v87
    v_add_f32 v76, v76, v88
    v_add_f32 v77, v77, v89
    v_add_f32 v78, v78, v90
    v_add_f32 v79, v79, v91
    v_add_f32 v68, v68, v72
    v_add_f32 v69, v69, v73
    v_add_f32 v70, v70, v74
    v_add_f32 v71, v71, v75
    v_add_f32 v68, v68, v76
    v_add_f32 v69, v69, v77
    v_add_f32 v70, v70, v78
    v_add_f32 v71, v71, v79
    v_cvt_pk_bf16_f32 v56, v68, v69
    v_cvt_pk_bf16_f32 v58, v70, v71
    s_mov_b64 exec, 0xffff
    buffer_store_dwordx4 v[56:59], v5, s[60:63], 0 offen sc1
    s_mov_b64 exec, -1
L_nopub:
    s_barrier
    s_lshl_b32 s12, s4, 2
    v_mov_b32 v7, s12
    v_mov_b32 v6, 1
    s_mov_b64 exec, 1
    buffer_atomic_add v6, v7, s[64:67], 0 offen offset:192 sc1
    s_mov_b64 exec, -1
    buffer_load_dwordx4 v[8:11], v2, s[44:47], s9 offen nt
    buffer_load_dwordx4 v[12:15], v2, s[44:47], s9 offen offset:128 nt
    s_add_u32 s9, s9, 32768
    buffer_load_dwordx4 v[16:19], v2, s[44:47], s9 offen nt
    buffer_load_dwordx4 v[20:23], v2, s[44:47], s9 offen offset:128 nt
    s_add_u32 s9, s9, 32768
    buffer_load_dwordx4 v[24:27], v2, s[44:47], s9 offen nt
    buffer_load_dwordx4 v[28:31], v2, s[44:47], s9 offen offset:128 nt
    s_add_u32 s9, s9, 32768
    s_branch L_q2join
L_q2poll:
    v_mov_b32 v5, 17408
    ds_read_b32 v56, v5
    s_lshl_b32 s12, s8, 10
    s_add_u32 s12, s12, 4096
    v_lshl_add_u32 v5, v1, 4, s12
    s_mov_b32 s96, 0
    s_waitcnt lgkmcnt(0)
    s_barrier
L_qpoll:
    buffer_load_dwordx4 v[60:63], v5, s[60:63], 0 offen sc1
    s_add_u32 s96, s96, 1
    s_waitcnt vmcnt(0)
    v_cmp_ne_u32 vcc, v56, v61
    v_cmp_ne_u32 s[98:99], v56, v63
    s_nop 3
    s_or_b64 vcc, vcc, s[98:99]
    s_cmp_eq_u64 vcc, 0
    s_cbranch_scc1 L_qgot
    s_cmp_lt_u32 s96, 400000
    s_cbranch_scc1 L_qpoll
L_qgot:
    v_mov_b32 v61, v62
    v_lshlrev_b32 v6, 3, v1
    ds_write_b64 v6, v[60:61] offset:16640
    buffer_load_dwordx4 v[8:11], v2, s[44:47], s9 offen nt
    buffer_load_dwordx4 v[12:15], v2, s[44:47], s9 offen offset:128 nt
    s_add_u32 s9, s9, 32768
    buffer_load_dwordx4 v[16:19], v2, s[44:47], s9 offen nt
    buffer_load_dwordx4 v[20:23], v2, s[44:47], s9 offen offset:128 nt
    s_add_u32 s9, s9, 32768
    buffer_load_dwordx4 v[24:27], v2, s[44:47], s9 offen nt
    buffer_load_dwordx4 v[28:31], v2, s[44:47], s9 offen offset:128 nt
    s_add_u32 s9, s9, 32768
    s_waitcnt lgkmcnt(0)
    s_branch L_q2join
L_q2other:
    s_barrier
    buffer_load_dwordx4 v[24:27], v2, s[44:47], s9 offen nt
    buffer_load_dwordx4 v[28:31], v2, s[44:47], s9 offen offset:128 nt
    s_add_u32 s9, s9, 32768
L_q2join:
    s_barrier
    buffer_load_dwordx4 v[32:35], v2, s[44:47], s9 offen nt
    buffer_load_dwordx4 v[36:39], v2, s[44:47], s9 offen offset:128 nt
    s_add_u32 s9, s9, 32768
    v_and_b32 v5, 7, v1
    v_lshlrev_b32 v5, 4, v5
    ds_read_b128 v[40:43], v5 offset:16640
    ds_read_b128 v[44:47], v5 offset:16768
    ds_read_b128 v[48:51], v5 offset:16896
    ds_read_b128 v[52:55], v5 offset:17024
    v_lshrrev_b32 v4, 2, v1
    v_lshl_add_u32 v4, v4, 2, s76
    s_waitcnt lgkmcnt(0)
    s_waitcnt vmcnt(6)
    v_mov_b32 v56, 0
    v_mov_b32 v57, 0
    v_dot2c_f32_bf16 v56, v8, v40
    v_dot2c_f32_bf16 v57, v8, v48
    v_dot2c_f32_bf16 v56, v9, v41
    v_dot2c_f32_bf16 v57, v9, v49
    v_dot2c_f32_bf16 v56, v10, v42
    v_dot2c_f32_bf16 v57, v10, v50
    v_dot2c_f32_bf16 v56, v11, v43
    v_dot2c_f32_bf16 v57, v11, v51
    v_dot2c_f32_bf16 v56, v12, v44
    v_dot2c_f32_bf16 v57, v12, v52
    v_dot2c_f32_bf16 v56, v13, v45
    v_dot2c_f32_bf16 v57, v13, v53
    v_dot2c_f32_bf16 v56, v14, v46
    v_dot2c_f32_bf16 v57, v14, v54
    v_dot2c_f32_bf16 v56, v15, v47
    v_dot2c_f32_bf16 v57, v15, v55
    s_nop 3
    v_add_f32_dpp v60, v56, v56 row_shl:4 row_mask:0xf bank_mask:0x5
    v_add_f32_dpp v60, v57, v57 row_shr:4 row_mask:0xf bank_mask:0xa
    s_nop 1
    v_add_f32_dpp v60, v60, v60 quad_perm:[1,0,3,2] row_mask:0xf bank_mask:0xf
    s_nop 1
    v_add_f32_dpp v60, v60, v60 quad_perm:[2,3,0,1] row_mask:0xf bank_mask:0xf
    ds_write_b32 v4, v60 offset:0
    s_barrier
    s_waitcnt vmcnt(4)
    v_mov_b32 v58, 0
    v_mov_b32 v59, 0
    v_dot2c_f32_bf16 v58, v16, v40
    v_dot2c_f32_bf16 v59, v16, v48
    v_dot2c_f32_bf16 v58, v17, v41
    v_dot2c_f32_bf16 v59, v17, v49
    v_dot2c_f32_bf16 v58, v18, v42
    v_dot2c_f32_bf16 v59, v18, v50
    v_dot2c_f32_bf16 v58, v19, v43
    v_dot2c_f32_bf16 v59, v19, v51
    v_dot2c_f32_bf16 v58, v20, v44
    v_dot2c_f32_bf16 v59, v20, v52
    v_dot2c_f32_bf16 v58, v21, v45
    v_dot2c_f32_bf16 v59, v21, v53
    v_dot2c_f32_bf16 v58, v22, v46
    v_dot2c_f32_bf16 v59, v22, v54
    v_dot2c_f32_bf16 v58, v23, v47
    v_dot2c_f32_bf16 v59, v23, v55
    s_nop 3
    v_add_f32_dpp v61, v58, v58 row_shl:4 row_mask:0xf bank_mask:0x5
    v_add_f32_dpp v61, v59, v59 row_shr:4 row_mask:0xf bank_mask:0xa
    s_nop 1
    v_add_f32_dpp v61, v61, v61 quad_perm:[1,0,3,2] row_mask:0xf bank_mask:0xf
    s_nop 1
    v_add_f32_dpp v61, v61, v61 quad_perm:[2,3,0,1] row_mask:0xf bank_mask:0xf
    ds_write_b32 v4, v61 offset:64
    s_barrier
    s_waitcnt vmcnt(2)
    v_mov_b32 v56, 0
    v_mov_b32 v57, 0
    v_dot2c_f32_bf16 v56, v24, v40
    v_dot2c_f32_bf16 v57, v24, v48
    v_dot2c_f32_bf16 v56, v25, v41
    v_dot2c_f32_bf16 v57, v25, v49
    v_dot2c_f32_bf16 v56, v26, v42
    v_dot2c_f32_bf16 v57, v26, v50
    v_dot2c_f32_bf16 v56, v27, v43
    v_dot2c_f32_bf16 v57, v27, v51
    v_dot2c_f32_bf16 v56, v28, v44
    v_dot2c_f32_bf16 v57, v28, v52
    v_dot2c_f32_bf16 v56, v29, v45
    v_dot2c_f32_bf16 v57, v29, v53
    v_dot2c_f32_bf16 v56, v30, v46
    v_dot2c_f32_bf16 v57, v30, v54
    v_dot2c_f32_bf16 v56, v31, v47
    v_dot2c_f32_bf16 v57, v31, v55
    buffer_load_dwordx4 v[8:11], v2, s[44:47], s9 offen nt
    buffer_load_dwordx4 v[12:15], v2, s[44:47], s9 offen offset:128 nt
    s_add_u32 s9, s9, 32768
    s_nop 0
    v_add_f32_dpp v60, v56, v56 row_shl:4 row_mask:0xf bank_mask:0x5
    v_add_f32_dpp v60, v57, v57 row_shr:4 row_mask:0xf bank_mask:0xa
    s_nop 1
    v_add_f32_dpp v60, v60, v60 quad_perm:[1,0,3,2] row_mask:0xf bank_mask:0xf
    s_nop 1
    v_add_f32_dpp v60, v60, v60 quad_perm:[2,3,0,1] row_mask:0xf bank_mask:0xf
    ds_write_b32 v4, v60 offset:128
    s_barrier
    s_waitcnt vmcnt(2)
    v_mov_b32 v58, 0
    v_mov_b32 v59, 0
    v_dot2c_f32_bf16 v58, v32, v40
    v_dot2c_f32_bf16 v59, v32, v48
    v_dot2c_f32_bf16 v58, v33, v41
    v_dot2c_f32_bf16 v59, v33, v49
    v_dot2c_f32_bf16 v58, v34, v42
    v_dot2c_f32_bf16 v59, v34, v50
    v_dot2c_f32_bf16 v58, v35, v43
    v_dot2c_f32_bf16 v59, v35, v51
    v_dot2c_f32_bf16 v58, v36, v44
    v_dot2c_f32_bf16 v59, v36, v52
    v_dot2c_f32_bf16 v58, v37, v45
    v_dot2c_f32_bf16 v59, v37, v53
    v_dot2c_f32_bf16 v58, v38, v46
    v_dot2c_f32_bf16 v59, v38, v54
    v_dot2c_f32_bf16 v58, v39, v47
    v_dot2c_f32_bf16 v59, v39, v55
    buffer_load_dwordx4 v[16:19], v2, s[44:47], s9 offen nt
    buffer_load_dwordx4 v[20:23], v2, s[44:47], s9 offen offset:128 nt
    s_add_u32 s9, s9, 32768
    s_nop 0
    v_add_f32_dpp v61, v58, v58 row_shl:4 row_mask:0xf bank_mask:0x5
    v_add_f32_dpp v61, v59, v59 row_shr:4 row_mask:0xf bank_mask:0xa
    s_nop 1
    v_add_f32_dpp v61, v61, v61 quad_perm:[1,0,3,2] row_mask:0xf bank_mask:0xf
    s_nop 1
    v_add_f32_dpp v61, v61, v61 quad_perm:[2,3,0,1] row_mask:0xf bank_mask:0xf
    ds_write_b32 v4, v61 offset:192
    s_barrier
    s_waitcnt vmcnt(2)
    v_mov_b32 v56, 0
    v_mov_b32 v57, 0
    v_dot2c_f32_bf16 v56, v8, v40
    v_dot2c_f32_bf16 v57, v8, v48
    v_dot2c_f32_bf16 v56, v9, v41
    v_dot2c_f32_bf16 v57, v9, v49
    v_dot2c_f32_bf16 v56, v10, v42
    v_dot2c_f32_bf16 v57, v10, v50
    v_dot2c_f32_bf16 v56, v11, v43
    v_dot2c_f32_bf16 v57, v11, v51
    v_dot2c_f32_bf16 v56, v12, v44
    v_dot2c_f32_bf16 v57, v12, v52
    v_dot2c_f32_bf16 v56, v13, v45
    v_dot2c_f32_bf16 v57, v13, v53
    v_dot2c_f32_bf16 v56, v14, v46
    v_dot2c_f32_bf16 v57, v14, v54
    v_dot2c_f32_bf16 v56, v15, v47
    v_dot2c_f32_bf16 v57, v15, v55
    buffer_load_dwordx4 v[24:27], v2, s[44:47], s9 offen nt
    buffer_load_dwordx4 v[28:31], v2, s[44:47], s9 offen offset:128 nt
    s_add_u32 s9, s9, 32768
    s_nop 0
    v_add_f32_dpp v60, v56, v56 row_shl:4 row_mask:0xf bank_mask:0x5
    v_add_f32_dpp v60, v57, v57 row_shr:4 row_mask:0xf bank_mask:0xa
    s_nop 1
    v_add_f32_dpp v60, v60, v60 quad_perm:[1,0,3,2] row_mask:0xf bank_mask:0xf
    s_nop 1
    v_add_f32_dpp v60, v60, v60 quad_perm:[2,3,0,1] row_mask:0xf bank_mask:0xf
    ds_write_b32 v4, v60 offset:256
    s_barrier
    s_waitcnt vmcnt(2)
    v_mov_b32 v58, 0
    v_mov_b32 v59, 0
    v_dot2c_f32_bf16 v58, v16, v40
    v_dot2c_f32_bf16 v59, v16, v48
    v_dot2c_f32_bf16 v58, v17, v41
    v_dot2c_f32_bf16 v59, v17, v49
    v_dot2c_f32_bf16 v58, v18, v42
    v_dot2c_f32_bf16 v59, v18, v50
    v_dot2c_f32_bf16 v58, v19, v43
    v_dot2c_f32_bf16 v59, v19, v51
    v_dot2c_f32_bf16 v58, v20, v44
    v_dot2c_f32_bf16 v59, v20, v52
    v_dot2c_f32_bf16 v58, v21, v45
    v_dot2c_f32_bf16 v59, v21, v53
    v_dot2c_f32_bf16 v58, v22, v46
    v_dot2c_f32_bf16 v59, v22, v54
    v_dot2c_f32_bf16 v58, v23, v47
    v_dot2c_f32_bf16 v59, v23, v55
    buffer_load_dwordx4 v[32:35], v2, s[44:47], s9 offen nt
    buffer_load_dwordx4 v[36:39], v2, s[44:47], s9 offen offset:128 nt
    s_add_u32 s9, s9, 32768
    s_nop 0
    v_add_f32_dpp v61, v58, v58 row_shl:4 row_mask:0xf bank_mask:0x5
    v_add_f32_dpp v61, v59, v59 row_shr:4 row_mask:0xf bank_mask:0xa
    s_nop 1
    v_add_f32_dpp v61, v61, v61 quad_perm:[1,0,3,2] row_mask:0xf bank_mask:0xf
    s_nop 1
    v_add_f32_dpp v61, v61, v61 quad_perm:[2,3,0,1] row_mask:0xf bank_mask:0xf
    ds_write_b32 v4, v61 offset:320
    s_barrier
    s_waitcnt vmcnt(2)
    v_mov_b32 v56, 0
    v_mov_b32 v57, 0
    v_dot2c_f32_bf16 v56, v24, v40
    v_dot2c_f32_bf16 v57, v24, v48
    v_dot2c_f32_bf16 v56, v25, v41
    v_dot2c_f32_bf16 v57, v25, v49
    v_dot2c_f32_bf16 v56, v26, v42
    v_dot2c_f32_bf16 v57, v26, v50
    v_dot2c_f32_bf16 v56, v27, v43
    v_dot2c_f32_bf16 v57, v27, v51
    v_dot2c_f32_bf16 v56, v28, v44
    v_dot2c_f32_bf16 v57, v28, v52
    v_dot2c_f32_bf16 v56, v29, v45
    v_dot2c_f32_bf16 v57, v29, v53
    v_dot2c_f32_bf16 v56, v30, v46
    v_dot2c_f32_bf16 v57, v30, v54
    v_dot2c_f32_bf16 v56, v31, v47
    v_dot2c_f32_bf16 v57, v31, v55
    buffer_load_dwordx4 v[8:11], v2, s[44:47], s9 offen nt
    buffer_load_dwordx4 v[12:15], v2, s[44:47], s9 offen offset:128 nt
    s_add_u32 s9, s9, 32768
    s_nop 0
    v_add_f32_dpp v60, v56, v56 row_shl:4 row_mask:0xf bank_mask:0x5
    v_add_f32_dpp v60, v57, v57 row_shr:4 row_mask:0xf bank_mask:0xa
    s_nop 1
    v_add_f32_dpp v60, v60, v60 quad_perm:[1,0,3,2] row_mask:0xf bank_mask:0xf
    s_nop 1
    v_add_f32_dpp v60, v60, v60 quad_perm:[2,3,0,1] row_mask:0xf bank_mask:0xf
    ds_write_b32 v4, v60 offset:384
    s_barrier
    s_waitcnt vmcnt(2)
    v_mov_b32 v58, 0
    v_mov_b32 v59, 0
    v_dot2c_f32_bf16 v58, v32, v40
    v_dot2c_f32_bf16 v59, v32, v48
    v_dot2c_f32_bf16 v58, v33, v41
    v_dot2c_f32_bf16 v59, v33, v49
    v_dot2c_f32_bf16 v58, v34, v42
    v_dot2c_f32_bf16 v59, v34, v50
    v_dot2c_f32_bf16 v58, v35, v43
    v_dot2c_f32_bf16 v59, v35, v51
    v_dot2c_f32_bf16 v58, v36, v44
    v_dot2c_f32_bf16 v59, v36, v52
    v_dot2c_f32_bf16 v58, v37, v45
    v_dot2c_f32_bf16 v59, v37, v53
    v_dot2c_f32_bf16 v58, v38, v46
    v_dot2c_f32_bf16 v59, v38, v54
    v_dot2c_f32_bf16 v58, v39, v47
    v_dot2c_f32_bf16 v59, v39, v55
    buffer_load_dwordx4 v[16:19], v2, s[44:47], s9 offen nt
    buffer_load_dwordx4 v[20:23], v2, s[44:47], s9 offen offset:128 nt
    s_add_u32 s9, s9, 32768
    s_nop 0
    v_add_f32_dpp v61, v58, v58 row_shl:4 row_mask:0xf bank_mask:0x5
    v_add_f32_dpp v61, v59, v59 row_shr:4 row_mask:0xf bank_mask:0xa
    s_nop 1
    v_add_f32_dpp v61, v61, v61 quad_perm:[1,0,3,2] row_mask:0xf bank_mask:0xf
    s_nop 1
    v_add_f32_dpp v61, v61, v61 quad_perm:[2,3,0,1] row_mask:0xf bank_mask:0xf
    ds_write_b32 v4, v61 offset:448
    s_barrier
    s_waitcnt vmcnt(2)
    v_mov_b32 v56, 0
    v_mov_b32 v57, 0
    v_dot2c_f32_bf16 v56, v8, v40
    v_dot2c_f32_bf16 v57, v8, v48
    v_dot2c_f32_bf16 v56, v9, v41
    v_dot2c_f32_bf16 v57, v9, v49
    v_dot2c_f32_bf16 v56, v10, v42
    v_dot2c_f32_bf16 v57, v10, v50
    v_dot2c_f32_bf16 v56, v11, v43
    v_dot2c_f32_bf16 v57, v11, v51
    v_dot2c_f32_bf16 v56, v12, v44
    v_dot2c_f32_bf16 v57, v12, v52
    v_dot2c_f32_bf16 v56, v13, v45
    v_dot2c_f32_bf16 v57, v13, v53
    v_dot2c_f32_bf16 v56, v14, v46
    v_dot2c_f32_bf16 v57, v14, v54
    v_dot2c_f32_bf16 v56, v15, v47
    v_dot2c_f32_bf16 v57, v15, v55
    buffer_load_dwordx4 v[24:27], v2, s[44:47], s9 offen nt
    buffer_load_dwordx4 v[28:31], v2, s[44:47], s9 offen offset:128 nt
    s_add_u32 s9, s9, 32768
    s_nop 0
    v_add_f32_dpp v60, v56, v56 row_shl:4 row_mask:0xf bank_mask:0x5
    v_add_f32_dpp v60, v57, v57 row_shr:4 row_mask:0xf bank_mask:0xa
    s_nop 1
    v_add_f32_dpp v60, v60, v60 quad_perm:[1,0,3,2] row_mask:0xf bank_mask:0xf
    s_nop 1
    v_add_f32_dpp v60, v60, v60 quad_perm:[2,3,0,1] row_mask:0xf bank_mask:0xf
    ds_write_b32 v4, v60 offset:512
    s_barrier
    s_waitcnt vmcnt(2)
    v_mov_b32 v58, 0
    v_mov_b32 v59, 0
    v_dot2c_f32_bf16 v58, v16, v40
    v_dot2c_f32_bf16 v59, v16, v48
    v_dot2c_f32_bf16 v58, v17, v41
    v_dot2c_f32_bf16 v59, v17, v49
    v_dot2c_f32_bf16 v58, v18, v42
    v_dot2c_f32_bf16 v59, v18, v50
    v_dot2c_f32_bf16 v58, v19, v43
    v_dot2c_f32_bf16 v59, v19, v51
    v_dot2c_f32_bf16 v58, v20, v44
    v_dot2c_f32_bf16 v59, v20, v52
    v_dot2c_f32_bf16 v58, v21, v45
    v_dot2c_f32_bf16 v59, v21, v53
    v_dot2c_f32_bf16 v58, v22, v46
    v_dot2c_f32_bf16 v59, v22, v54
    v_dot2c_f32_bf16 v58, v23, v47
    v_dot2c_f32_bf16 v59, v23, v55
    buffer_load_dwordx4 v[32:35], v2, s[44:47], s9 offen nt
    buffer_load_dwordx4 v[36:39], v2, s[44:47], s9 offen offset:128 nt
    s_add_u32 s9, s9, 32768
    s_nop 0
    v_add_f32_dpp v61, v58, v58 row_shl:4 row_mask:0xf bank_mask:0x5
    v_add_f32_dpp v61, v59, v59 row_shr:4 row_mask:0xf bank_mask:0xa
    s_nop 1
    v_add_f32_dpp v61, v61, v61 quad_perm:[1,0,3,2] row_mask:0xf bank_mask:0xf
    s_nop 1
    v_add_f32_dpp v61, v61, v61 quad_perm:[2,3,0,1] row_mask:0xf bank_mask:0xf
    ds_write_b32 v4, v61 offset:576
    s_cmp_ge_u32 s3, 8
    s_cbranch_scc1 L_nowo1
    buffer_load_dwordx4 v[64:67], v126, s[56:59], 0 offen offset:0 nt
    buffer_load_dwordx4 v[72:75], v126, s[56:59], 0 offen offset:1152 nt
    buffer_load_dwordx4 v[68:71], v126, s[56:59], 0 offen offset:512 nt
    buffer_load_dwordx4 v[76:79], v126, s[56:59], 0 offen offset:1664 nt
    buffer_load_dword v80, v125, s[56:59], 0 offen offset:1024 nt
    buffer_load_dword v81, v125, s[56:59], 0 offen offset:2176 nt
L_nowo1:
    s_barrier
    s_waitcnt vmcnt(2)
    v_mov_b32 v56, 0
    v_mov_b32 v57, 0
    v_dot2c_f32_bf16 v56, v24, v40
    v_dot2c_f32_bf16 v57, v24, v48
    v_dot2c_f32_bf16 v56, v25, v41
    v_dot2c_f32_bf16 v57, v25, v49
    v_dot2c_f32_bf16 v56, v26, v42
    v_dot2c_f32_bf16 v57, v26, v50
    v_dot2c_f32_bf16 v56, v27, v43
    v_dot2c_f32_bf16 v57, v27, v51
    v_dot2c_f32_bf16 v56, v28, v44
    v_dot2c_f32_bf16 v57, v28, v52
    v_dot2c_f32_bf16 v56, v29, v45
    v_dot2c_f32_bf16 v57, v29, v53
    v_dot2c_f32_bf16 v56, v30, v46
    v_dot2c_f32_bf16 v57, v30, v54
    v_dot2c_f32_bf16 v56, v31, v47
    v_dot2c_f32_bf16 v57, v31, v55
    buffer_load_dwordx4 v[8:11], v2, s[44:47], s9 offen nt
    buffer_load_dwordx4 v[12:15], v2, s[44:47], s9 offen offset:128 nt
    s_add_u32 s9, s9, 32768
    s_nop 0
    v_add_f32_dpp v60, v56, v56 row_shl:4 row_mask:0xf bank_mask:0x5
    v_add_f32_dpp v60, v57, v57 row_shr:4 row_mask:0xf bank_mask:0xa
    s_nop 1
    v_add_f32_dpp v60, v60, v60 quad_perm:[1,0,3,2] row_mask:0xf bank_mask:0xf
    s_nop 1
    v_add_f32_dpp v60, v60, v60 quad_perm:[2,3,0,1] row_mask:0xf bank_mask:0xf
    ds_write_b32 v4, v60 offset:640
    s_barrier
    s_waitcnt vmcnt(2)
    v_mov_b32 v58, 0
    v_mov_b32 v59, 0
    v_dot2c_f32_bf16 v58, v32, v40
    v_dot2c_f32_bf16 v59, v32, v48
    v_dot2c_f32_bf16 v58, v33, v41
    v_dot2c_f32_bf16 v59, v33, v49
    v_dot2c_f32_bf16 v58, v34, v42
    v_dot2c_f32_bf16 v59, v34, v50
    v_dot2c_f32_bf16 v58, v35, v43
    v_dot2c_f32_bf16 v59, v35, v51
    v_dot2c_f32_bf16 v58, v36, v44
    v_dot2c_f32_bf16 v59, v36, v52
    v_dot2c_f32_bf16 v58, v37, v45
    v_dot2c_f32_bf16 v59, v37, v53
    v_dot2c_f32_bf16 v58, v38, v46
    v_dot2c_f32_bf16 v59, v38, v54
    v_dot2c_f32_bf16 v58, v39, v47
    v_dot2c_f32_bf16 v59, v39, v55
    buffer_load_dwordx4 v[16:19], v2, s[44:47], s9 offen nt
    buffer_load_dwordx4 v[20:23], v2, s[44:47], s9 offen offset:128 nt
    s_add_u32 s9, s9, 32768
    s_nop 0
    v_add_f32_dpp v61, v58, v58 row_shl:4 row_mask:0xf bank_mask:0x5
    v_add_f32_dpp v61, v59, v59 row_shr:4 row_mask:0xf bank_mask:0xa
    s_nop 1
    v_add_f32_dpp v61, v61, v61 quad_perm:[1,0,3,2] row_mask:0xf bank_mask:0xf
    s_nop 1
    v_add_f32_dpp v61, v61, v61 quad_perm:[2,3,0,1] row_mask:0xf bank_mask:0xf
    ds_write_b32 v4, v61 offset:704
    s_barrier
    s_waitcnt vmcnt(2)
    v_mov_b32 v56, 0
    v_mov_b32 v57, 0
    v_dot2c_f32_bf16 v56, v8, v40
    v_dot2c_f32_bf16 v57, v8, v48
    v_dot2c_f32_bf16 v56, v9, v41
    v_dot2c_f32_bf16 v57, v9, v49
    v_dot2c_f32_bf16 v56, v10, v42
    v_dot2c_f32_bf16 v57, v10, v50
    v_dot2c_f32_bf16 v56, v11, v43
    v_dot2c_f32_bf16 v57, v11, v51
    v_dot2c_f32_bf16 v56, v12, v44
    v_dot2c_f32_bf16 v57, v12, v52
    v_dot2c_f32_bf16 v56, v13, v45
    v_dot2c_f32_bf16 v57, v13, v53
    v_dot2c_f32_bf16 v56, v14, v46
    v_dot2c_f32_bf16 v57, v14, v54
    v_dot2c_f32_bf16 v56, v15, v47
    v_dot2c_f32_bf16 v57, v15, v55
    buffer_load_dwordx4 v[24:27], v2, s[44:47], s9 offen nt
    buffer_load_dwordx4 v[28:31], v2, s[44:47], s9 offen offset:128 nt
    s_add_u32 s9, s9, 32768
    s_nop 0
    v_add_f32_dpp v60, v56, v56 row_shl:4 row_mask:0xf bank_mask:0x5
    v_add_f32_dpp v60, v57, v57 row_shr:4 row_mask:0xf bank_mask:0xa
    s_nop 1
    v_add_f32_dpp v60, v60, v60 quad_perm:[1,0,3,2] row_mask:0xf bank_mask:0xf
    s_nop 1
    v_add_f32_dpp v60, v60, v60 quad_perm:[2,3,0,1] row_mask:0xf bank_mask:0xf
    ds_write_b32 v4, v60 offset:768
    s_barrier
    s_waitcnt vmcnt(2)
    v_mov_b32 v58, 0
    v_mov_b32 v59, 0
    v_dot2c_f32_bf16 v58, v16, v40
    v_dot2c_f32_bf16 v59, v16, v48
    v_dot2c_f32_bf16 v58, v17, v41
    v_dot2c_f32_bf16 v59, v17, v49
    v_dot2c_f32_bf16 v58, v18, v42
    v_dot2c_f32_bf16 v59, v18, v50
    v_dot2c_f32_bf16 v58, v19, v43
    v_dot2c_f32_bf16 v59, v19, v51
    v_dot2c_f32_bf16 v58, v20, v44
    v_dot2c_f32_bf16 v59, v20, v52
    v_dot2c_f32_bf16 v58, v21, v45
    v_dot2c_f32_bf16 v59, v21, v53
    v_dot2c_f32_bf16 v58, v22, v46
    v_dot2c_f32_bf16 v59, v22, v54
    v_dot2c_f32_bf16 v58, v23, v47
    v_dot2c_f32_bf16 v59, v23, v55
    buffer_load_dwordx4 v[32:35], v2, s[44:47], s9 offen nt
    buffer_load_dwordx4 v[36:39], v2, s[44:47], s9 offen offset:128 nt
    s_add_u32 s9, s9, 32768
    s_nop 0
    v_add_f32_dpp v61, v58, v58 row_shl:4 row_mask:0xf bank_mask:0x5
    v_add_f32_dpp v61, v59, v59 row_shr:4 row_mask:0xf bank_mask:0xa
    s_nop 1
    v_add_f32_dpp v61, v61, v61 quad_perm:[1,0,3,2] row_mask:0xf bank_mask:0xf
    s_nop 1
    v_add_f32_dpp v61, v61, v61 quad_perm:[2,3,0,1] row_mask:0xf bank_mask:0xf
    ds_write_b32 v4, v61 offset:832
    s_barrier
    s_waitcnt vmcnt(2)
    v_mov_b32 v56, 0
    v_mov_b32 v57, 0
    v_dot2c_f32_bf16 v56, v24, v40
    v_dot2c_f32_bf16 v57, v24, v48
    v_dot2c_f32_bf16 v56, v25, v41
    v_dot2c_f32_bf16 v57, v25, v49
    v_dot2c_f32_bf16 v56, v26, v42
    v_dot2c_f32_bf16 v57, v26, v50
    v_dot2c_f32_bf16 v56, v27, v43
    v_dot2c_f32_bf16 v57, v27, v51
    v_dot2c_f32_bf16 v56, v28, v44
    v_dot2c_f32_bf16 v57, v28, v52
    v_dot2c_f32_bf16 v56, v29, v45
    v_dot2c_f32_bf16 v57, v29, v53
    v_dot2c_f32_bf16 v56, v30, v46
    v_dot2c_f32_bf16 v57, v30, v54
    v_dot2c_f32_bf16 v56, v31, v47
    v_dot2c_f32_bf16 v57, v31, v55
    s_mov_b32 s9, 0
    buffer_load_dwordx4 v[8:11], v3, s[48:51], s9 offen nt
    buffer_load_dwordx4 v[12:15], v3, s[48:51], s9 offen offset:256 nt
    s_add_u32 s9, s9, 32768
    s_nop 0
    v_add_f32_dpp v60, v56, v56 row_shl:4 row_mask:0xf bank_mask:0x5
    v_add_f32_dpp v60, v57, v57 row_shr:4 row_mask:0xf bank_mask:0xa
    s_nop 1
    v_add_f32_dpp v60, v60, v60 quad_perm:[1,0,3,2] row_mask:0xf bank_mask:0xf
    s_nop 1
    v_add_f32_dpp v60, v60, v60 quad_perm:[2,3,0,1] row_mask:0xf bank_mask:0xf
    ds_write_b32 v4, v60 offset:896
    s_barrier
    s_waitcnt vmcnt(2)
    v_mov_b32 v58, 0
    v_mov_b32 v59, 0
    v_dot2c_f32_bf16 v58, v32, v40
    v_dot2c_f32_bf16 v59, v32, v48
    v_dot2c_f32_bf16 v58, v33, v41
    v_dot2c_f32_bf16 v59, v33, v49
    v_dot2c_f32_bf16 v58, v34, v42
    v_dot2c_f32_bf16 v59, v34, v50
    v_dot2c_f32_bf16 v58, v35, v43
    v_dot2c_f32_bf16 v59, v35, v51
    v_dot2c_f32_bf16 v58, v36, v44
    v_dot2c_f32_bf16 v59, v36, v52
    v_dot2c_f32_bf16 v58, v37, v45
    v_dot2c_f32_bf16 v59, v37, v53
    v_dot2c_f32_bf16 v58, v38, v46
    v_dot2c_f32_bf16 v59, v38, v54
    v_dot2c_f32_bf16 v58, v39, v47
    v_dot2c_f32_bf16 v59, v39, v55
    buffer_load_dwordx4 v[16:19], v3, s[48:51], s9 offen nt
    buffer_load_dwordx4 v[20:23], v3, s[48:51], s9 offen offset:256 nt
    s_add_u32 s9, s9, 32768
    s_nop 0
    v_add_f32_dpp v61, v58, v58 row_shl:4 row_mask:0xf bank_mask:0x5
    v_add_f32_dpp v61, v59, v59 row_shr:4 row_mask:0xf bank_mask:0xa
    s_nop 1
    v_add_f32_dpp v61, v61, v61 quad_perm:[1,0,3,2] row_mask:0xf bank_mask:0xf
    s_nop 1
    v_add_f32_dpp v61, v61, v61 quad_perm:[2,3,0,1] row_mask:0xf bank_mask:0xf
    ds_write_b32 v4, v61 offset:960
    s_barrier
    v_lshl_add_u32 v5, v1, 4, s76
    s_waitcnt lgkmcnt(0)
    ds_read_b128 v[104:107], v5
    s_waitcnt lgkmcnt(0)
    v_cvt_pk_bf16_f32 v112, v104, v105
    v_cvt_pk_bf16_f32 v113, v106, v107
    v_lshlrev_b32 v104, 16, v112
    v_and_b32 v105, s97, v112
    v_lshlrev_b32 v106, 16, v113
    v_and_b32 v107, s97, v113
    v_mul_f32 v104, s94, v104
    v_mul_f32 v105, s94, v105
    v_mul_f32 v106, s94, v106
    v_mul_f32 v107, s94, v107
    v_cvt_pk_bf16_f32 v112, v104, v105
    v_cvt_pk_bf16_f32 v113, v106, v107
    v_lshlrev_b32 v104, 16, v112
    v_and_b32 v105, s97, v112
    v_lshlrev_b32 v106, 16, v113
    v_and_b32 v107, s97, v113
    v_max_f32 v108, v104, v106
    v_max_f32 v109, v105, v107
    s_nop 1
    v_max_f32_dpp v108, v108, v108 quad_perm:[1,0,3,2] row_mask:0xf bank_mask:0xf
    v_max_f32_dpp v109, v109, v109 quad_perm:[1,0,3,2] row_mask:0xf bank_mask:0xf
    s_nop 1
    v_max_f32_dpp v108, v108, v108 quad_perm:[2,3,0,1] row_mask:0xf bank_mask:0xf
    v_max_f32_dpp v109, v109, v109 quad_perm:[2,3,0,1] row_mask:0xf bank_mask:0xf
    s_nop 1
    v_max_f32_dpp v108, v108, v108 row_half_mirror row_mask:0xf bank_mask:0xf
    v_max_f32_dpp v109, v109, v109 row_half_mirror row_mask:0xf bank_mask:0xf
    s_nop 1
    v_max_f32_dpp v108, v108, v108 row_mirror row_mask:0xf bank_mask:0xf
    v_max_f32_dpp v109, v109, v109 row_mirror row_mask:0xf bank_mask:0xf
    v_mov_b32 v112, v108
    v_mov_b32 v113, v109
    s_nop 1
    v_permlane16_swap_b32 v108, v112
    v_permlane16_swap_b32 v109, v113
    s_nop 1
    v_max_f32 v108, v108, v112
    v_max_f32 v109, v109, v113
    v_mov_b32 v112, v108
    v_mov_b32 v113, v109
    s_nop 1
    v_permlane32_swap_b32 v108, v112
    v_permlane32_swap_b32 v109, v113
    s_nop 1
    v_max_f32 v108, v108, v112
    v_max_f32 v109, v109, v113
    v_sub_f32 v104, v104, v108
    v_sub_f32 v105, v105, v109
    v_sub_f32 v106, v106, v108
    v_sub_f32 v107, v107, v109
    v_mul_f32 v104, s95, v104
    v_mul_f32 v105, s95, v105
    v_mul_f32 v106, s95, v106
    v_mul_f32 v107, s95, v107
    v_exp_f32 v104, v104
    v_exp_f32 v105, v105
    v_exp_f32 v106, v106
    v_exp_f32 v107, v107
    s_nop 0
    v_add_f32 v110, v104, v106
    v_add_f32 v111, v105, v107
    v_cvt_pk_bf16_f32 v114, v104, v106
    v_cvt_pk_bf16_f32 v115, v105, v107
    v_lshl_add_u32 v5, v1, 3, s76
    ds_write_b64 v5, v[114:115]
    s_nop 1
    v_add_f32_dpp v110, v110, v110 quad_perm:[1,0,3,2] row_mask:0xf bank_mask:0xf
    v_add_f32_dpp v111, v111, v111 quad_perm:[1,0,3,2] row_mask:0xf bank_mask:0xf
    s_nop 1
    v_add_f32_dpp v110, v110, v110 quad_perm:[2,3,0,1] row_mask:0xf bank_mask:0xf
    v_add_f32_dpp v111, v111, v111 quad_perm:[2,3,0,1] row_mask:0xf bank_mask:0xf
    s_nop 1
    v_add_f32_dpp v110, v110, v110 row_half_mirror row_mask:0xf bank_mask:0xf
    v_add_f32_dpp v111, v111, v111 row_half_mirror row_mask:0xf bank_mask:0xf
    s_nop 1
    v_add_f32_dpp v110, v110, v110 row_mirror row_mask:0xf bank_mask:0xf
    v_add_f32_dpp v111, v111, v111 row_mirror row_mask:0xf bank_mask:0xf
    v_mov_b32 v112, v110
    v_mov_b32 v113, v111
    s_nop 1
    v_permlane16_swap_b32 v110, v112
    v_permlane16_swap_b32 v111, v113
    s_nop 1
    v_add_f32 v110, v110, v112
    v_add_f32 v111, v111, v113
    v_mov_b32 v112, v110
    v_mov_b32 v113, v111
    s_nop 1
    v_permlane32_swap_b32 v110, v112
    v_permlane32_swap_b32 v111, v113
    s_nop 1
    v_add_f32 v110, v110, v112
    v_add_f32 v111, v111, v113
    v_mov_b32 v104, v108
    v_mov_b32 v105, v110
    v_mov_b32 v106, v109
    v_mov_b32 v107, v111
    s_lshl_b32 s13, s3, 4
    v_mov_b32 v5, s13
    s_mov_b64 exec, 1
    ds_write_b128 v5, v[104:107] offset:17152
    s_mov_b64 exec, -1
    v_lshrrev_b32 v4, 4, v1
    v_lshl_add_u32 v4, v4, 3, s76
    v_mov_b32 v40, 0
    v_mov_b32 v41, 0
    v_mov_b32 v42, 0
    v_mov_b32 v43, 0
    v_mov_b32 v44, 0
    v_mov_b32 v45, 0
    v_mov_b32 v46, 0
    v_mov_b32 v47, 0
    v_mov_b32 v48, 0
    v_mov_b32 v49, 0
    v_mov_b32 v50, 0
    v_mov_b32 v51, 0
    v_mov_b32 v52, 0
    v_mov_b32 v53, 0
    v_mov_b32 v54, 0
    v_mov_b32 v55, 0
    s_waitcnt lgkmcnt(0)
    ds_read_b64 v[114:115], v4 offset:0
    ds_read_b64 v[116:117], v4 offset:32
    ds_read_b64 v[118:119], v4 offset:64
    ds_read_b64 v[120:121], v4 offset:96
    s_waitcnt vmcnt(2) lgkmcnt(0)
    v_perm_b32 v56, v12, v8, s90
    v_perm_b32 v57, v12, v8, s91
    v_perm_b32 v58, v13, v9, s90
    v_perm_b32 v59, v13, v9, s91
    v_perm_b32 v60, v14, v10, s90
    v_perm_b32 v61, v14, v10, s91
    v_perm_b32 v62, v15, v11, s90
    v_perm_b32 v63, v15, v11, s91
    buffer_load_dwordx4 v[24:27], v3, s[48:51], s9 offen nt
    buffer_load_dwordx4 v[28:31], v3, s[48:51], s9 offen offset:256 nt
    s_add_u32 s9, s9, 32768
    v_dot2c_f32_bf16 v40, v114, v56
    v_dot2c_f32_bf16 v48, v115, v56
    v_dot2c_f32_bf16 v41, v114, v57
    v_dot2c_f32_bf16 v49, v115, v57
    v_dot2c_f32_bf16 v42, v114, v58
    v_dot2c_f32_bf16 v50, v115, v58
    v_dot2c_f32_bf16 v43, v114, v59
    v_dot2c_f32_bf16 v51, v115, v59
    v_dot2c_f32_bf16 v44, v114, v60
    v_dot2c_f32_bf16 v52, v115, v60
    v_dot2c_f32_bf16 v45, v114, v61
    v_dot2c_f32_bf16 v53, v115, v61
    v_dot2c_f32_bf16 v46, v114, v62
    v_dot2c_f32_bf16 v54, v115, v62
    v_dot2c_f32_bf16 v47, v114, v63
    v_dot2c_f32_bf16 v55, v115, v63
    s_barrier
    s_waitcnt vmcnt(2)
    v_perm_b32 v56, v20, v16, s90
    v_perm_b32 v57, v20, v16, s91
    v_perm_b32 v58, v21, v17, s90
    v_perm_b32 v59, v21, v17, s91
    v_perm_b32 v60, v22, v18, s90
    v_perm_b32 v61, v22, v18, s91
    v_perm_b32 v62, v23, v19, s90
    v_perm_b32 v63, v23, v19, s91
    buffer_load_dwordx4 v[32:35], v3, s[48:51], s9 offen nt
    buffer_load_dwordx4 v[36:39], v3, s[48:51], s9 offen offset:256 nt
    s_add_u32 s9, s9, 32768
    v_dot2c_f32_bf16 v40, v116, v56
    v_dot2c_f32_bf16 v48, v117, v56
    v_dot2c_f32_bf16 v41, v116, v57
    v_dot2c_f32_bf16 v49, v117, v57
    v_dot2c_f32_bf16 v42, v116, v58
    v_dot2c_f32_bf16 v50, v117, v58
    v_dot2c_f32_bf16 v43, v116, v59
    v_dot2c_f32_bf16 v51, v117, v59
    v_dot2c_f32_bf16 v44, v116, v60
    v_dot2c_f32_bf16 v52, v117, v60
    v_dot2c_f32_bf16 v45, v116, v61
    v_dot2c_f32_bf16 v53, v117, v61
    v_dot2c_f32_bf16 v46, v116, v62
    v_dot2c_f32_bf16 v54, v117, v62
    v_dot2c_f32_bf16 v47, v116, v63
    v_dot2c_f32_bf16 v55, v117, v63
    s_barrier
    s_waitcnt vmcnt(2)
    v_perm_b32 v56, v28, v24, s90
    v_perm_b32 v57, v28, v24, s91
    v_perm_b32 v58, v29, v25, s90
    v_perm_b32 v59, v29, v25, s91
    v_perm_b32 v60, v30, v26, s90
    v_perm_b32 v61, v30, v26, s91
    v_perm_b32 v62, v31, v27, s90
    v_perm_b32 v63, v31, v27, s91
    buffer_load_dwordx4 v[8:11], v3, s[48:51], s9 offen nt
    buffer_load_dwordx4 v[12:15], v3, s[48:51], s9 offen offset:256 nt
    s_add_u32 s9, s9, 32768
    v_dot2c_f32_bf16 v40, v118, v56
    v_dot2c_f32_bf16 v48, v119, v56
    v_dot2c_f32_bf16 v41, v118, v57
    v_dot2c_f32_bf16 v49, v119, v57
    v_dot2c_f32_bf16 v42, v118, v58
    v_dot2c_f32_bf16 v50, v119, v58
    v_dot2c_f32_bf16 v43, v118, v59
    v_dot2c_f32_bf16 v51, v119, v59
    v_dot2c_f32_bf16 v44, v118, v60
    v_dot2c_f32_bf16 v52, v119, v60
    v_dot2c_f32_bf16 v45, v118, v61
    v_dot2c_f32_bf16 v53, v119, v61
    v_dot2c_f32_bf16 v46, v118, v62
    v_dot2c_f32_bf16 v54, v119, v62
    v_dot2c_f32_bf16 v47, v118, v63
    v_dot2c_f32_bf16 v55, v119, v63
    s_barrier
    s_waitcnt vmcnt(2)
    v_perm_b32 v56, v36, v32, s90
    v_perm_b32 v57, v36, v32, s91
    v_perm_b32 v58, v37, v33, s90
    v_perm_b32 v59, v37, v33, s91
    v_perm_b32 v60, v38, v34, s90
    v_perm_b32 v61, v38, v34, s91
    v_perm_b32 v62, v39, v35, s90
    v_perm_b32 v63, v39, v35, s91
    buffer_load_dwordx4 v[16:19], v3, s[48:51], s9 offen nt
    buffer_load_dwordx4 v[20:23], v3, s[48:51], s9 offen offset:256 nt
    s_add_u32 s9, s9, 32768
    v_dot2c_f32_bf16 v40, v120, v56
    v_dot2c_f32_bf16 v48, v121, v56
    v_dot2c_f32_bf16 v41, v120, v57
    v_dot2c_f32_bf16 v49, v121, v57
    v_dot2c_f32_bf16 v42, v120, v58
    v_dot2c_f32_bf16 v50, v121, v58
    v_dot2c_f32_bf16 v43, v120, v59
    v_dot2c_f32_bf16 v51, v121, v59
    v_dot2c_f32_bf16 v44, v120, v60
    v_dot2c_f32_bf16 v52, v121, v60
    v_dot2c_f32_bf16 v45, v120, v61
    v_dot2c_f32_bf16 v53, v121, v61
    v_dot2c_f32_bf16 v46, v120, v62
    v_dot2c_f32_bf16 v54, v121, v62
    v_dot2c_f32_bf16 v47, v120, v63
    v_dot2c_f32_bf16 v55, v121, v63
    v_perm_b32 v104, v72, v64, s90
    v_perm_b32 v72, v72, v64, s91
    v_mov_b32 v64, v104
    v_perm_b32 v105, v73, v65, s90
    v_perm_b32 v73, v73, v65, s91
    v_mov_b32 v65, v105
    v_perm_b32 v106, v74, v66, s90
    v_perm_b32 v74, v74, v66, s91
    v_mov_b32 v66, v106
    v_perm_b32 v107, v75, v67, s90
    v_perm_b32 v75, v75, v67, s91
    v_mov_b32 v67, v107
    v_perm_b32 v104, v76, v68, s90
    v_perm_b32 v76, v76, v68, s91
    v_mov_b32 v68, v104
    v_perm_b32 v105, v77, v69, s90
    v_perm_b32 v77, v77, v69, s91
    v_mov_b32 v69, v105
    v_perm_b32 v106, v78, v70, s90
    v_perm_b32 v78, v78, v70, s91
    v_mov_b32 v70, v106
    v_perm_b32 v107, v79, v71, s90
    v_perm_b32 v79, v79, v71, s91
    v_mov_b32 v71, v107
    v_perm_b32 v104, v81, v80, s90
    v_perm_b32 v81, v81, v80, s91
    v_mov_b32 v80, v104
    s_barrier
    ds_read_b64 v[114:115], v4 offset:128
    ds_read_b64 v[116:117], v4 offset:160
    ds_read_b64 v[118:119], v4 offset:192
    ds_read_b64 v[120:121], v4 offset:224
    s_waitcnt vmcnt(2) lgkmcnt(0)
    v_perm_b32 v56, v12, v8, s90
    v_perm_b32 v57, v12, v8, s91
    v_perm_b32 v58, v13, v9, s90
    v_perm_b32 v59, v13, v9, s91
    v_perm_b32 v60, v14, v10, s90
    v_perm_b32 v61, v14, v10, s91
    v_perm_b32 v62, v15, v11, s90
    v_perm_b32 v63, v15, v11, s91
    buffer_load_dwordx4 v[24:27], v3, s[48:51], s9 offen nt
    buffer_load_dwordx4 v[28:31], v3, s[48:51], s9 offen offset:256 nt
    s_add_u32 s9, s9, 32768
    v_dot2c_f32_bf16 v40, v114, v56
    v_dot2c_f32_bf16 v48, v115, v56
    v_dot2c_f32_bf16 v41, v114, v57
    v_dot2c_f32_bf16 v49, v115, v57
    v_dot2c_f32_bf16 v42, v114, v58
    v_dot2c_f32_bf16 v50, v115, v58
    v_dot2c_f32_bf16 v43, v114, v59
    v_dot2c_f32_bf16 v51, v115, v59
    v_dot2c_f32_bf16 v44, v114, v60
    v_dot2c_f32_bf16 v52, v115, v60
    v_dot2c_f32_bf16 v45, v114, v61
    v_dot2c_f32_bf16 v53, v115, v61
    v_dot2c_f32_bf16 v46, v114, v62
    v_dot2c_f32_bf16 v54, v115, v62
    v_dot2c_f32_bf16 v47, v114, v63
    v_dot2c_f32_bf16 v55, v115, v63
    s_barrier
    s_waitcnt vmcnt(2)
    v_perm_b32 v56, v20, v16, s90
    v_perm_b32 v57, v20, v16, s91
    v_perm_b32 v58, v21, v17, s90
    v_perm_b32 v59, v21, v17, s91
    v_perm_b32 v60, v22, v18, s90
    v_perm_b32 v61, v22, v18, s91
    v_perm_b32 v62, v23, v19, s90
    v_perm_b32 v63, v23, v19, s91
    buffer_load_dwordx4 v[32:35], v3, s[48:51], s9 offen nt
    buffer_load_dwordx4 v[36:39], v3, s[48:51], s9 offen offset:256 nt
    s_add_u32 s9, s9, 32768
    v_dot2c_f32_bf16 v40, v116, v56
    v_dot2c_f32_bf16 v48, v117, v56
    v_dot2c_f32_bf16 v41, v116, v57
    v_dot2c_f32_bf16 v49, v117, v57
    v_dot2c_f32_bf16 v42, v116, v58
    v_dot2c_f32_bf16 v50, v117, v58
    v_dot2c_f32_bf16 v43, v116, v59
    v_dot2c_f32_bf16 v51, v117, v59
    v_dot2c_f32_bf16 v44, v116, v60
    v_dot2c_f32_bf16 v52, v117, v60
    v_dot2c_f32_bf16 v45, v116, v61
    v_dot2c_f32_bf16 v53, v117, v61
    v_dot2c_f32_bf16 v46, v116, v62
    v_dot2c_f32_bf16 v54, v117, v62
    v_dot2c_f32_bf16 v47, v116, v63
    v_dot2c_f32_bf16 v55, v117, v63
    s_barrier
    s_waitcnt vmcnt(2)
    v_perm_b32 v56, v28, v24, s90
    v_perm_b32 v57, v28, v24, s91
    v_perm_b32 v58, v29, v25, s90
    v_perm_b32 v59, v29, v25, s91
    v_perm_b32 v60, v30, v26, s90
    v_perm_b32 v61, v30, v26, s91
    v_perm_b32 v62, v31, v27, s90
    v_perm_b32 v63, v31, v27, s91
    buffer_load_dwordx4 v[8:11], v3, s[48:51], s9 offen nt
    buffer_load_dwordx4 v[12:15], v3, s[48:51], s9 offen offset:256 nt
    s_add_u32 s9, s9, 32768
    v_dot2c_f32_bf16 v40, v118, v56
    v_dot2c_f32_bf16 v48, v119, v56
    v_dot2c_f32_bf16 v41, v118, v57
    v_dot2c_f32_bf16 v49, v119, v57
    v_dot2c_f32_bf16 v42, v118, v58
    v_dot2c_f32_bf16 v50, v119, v58
    v_dot2c_f32_bf16 v43, v118, v59
    v_dot2c_f32_bf16 v51, v119, v59
    v_dot2c_f32_bf16 v44, v118, v60
    v_dot2c_f32_bf16 v52, v119, v60
    v_dot2c_f32_bf16 v45, v118, v61
    v_dot2c_f32_bf16 v53, v119, v61
    v_dot2c_f32_bf16 v46, v118, v62
    v_dot2c_f32_bf16 v54, v119, v62
    v_dot2c_f32_bf16 v47, v118, v63
    v_dot2c_f32_bf16 v55, v119, v63
    s_barrier
    s_waitcnt vmcnt(2)
    v_perm_b32 v56, v36, v32, s90
    v_perm_b32 v57, v36, v32, s91
    v_perm_b32 v58, v37, v33, s90
    v_perm_b32 v59, v37, v33, s91
    v_perm_b32 v60, v38, v34, s90
    v_perm_b32 v61, v38, v34, s91
    v_perm_b32 v62, v39, v35, s90
    v_perm_b32 v63, v39, v35, s91
    buffer_load_dwordx4 v[16:19], v3, s[48:51], s9 offen nt
    buffer_load_dwordx4 v[20:23], v3, s[48:51], s9 offen offset:256 nt
    s_add_u32 s9, s9, 32768
    v_dot2c_f32_bf16 v40, v120, v56
    v_dot2c_f32_bf16 v48, v121, v56
    v_dot2c_f32_bf16 v41, v120, v57
    v_dot2c_f32_bf16 v49, v121, v57
    v_dot2c_f32_bf16 v42, v120, v58
    v_dot2c_f32_bf16 v50, v121, v58
    v_dot2c_f32_bf16 v43, v120, v59
    v_dot2c_f32_bf16 v51, v121, v59
    v_dot2c_f32_bf16 v44, v120, v60
    v_dot2c_f32_bf16 v52, v121, v60
    v_dot2c_f32_bf16 v45, v120, v61
    v_dot2c_f32_bf16 v53, v121, v61
    v_dot2c_f32_bf16 v46, v120, v62
    v_dot2c_f32_bf16 v54, v121, v62
    v_dot2c_f32_bf16 v47, v120, v63
    v_dot2c_f32_bf16 v55, v121, v63
    s_barrier
    ds_read_b64 v[114:115], v4 offset:256
    ds_read_b64 v[116:117], v4 offset:288
    ds_read_b64 v[118:119], v4 offset:320
    ds_read_b64 v[120:121], v4 offset:352
    s_waitcnt vmcnt(2) lgkmcnt(0)
    v_perm_b32 v56, v12, v8, s90
    v_perm_b32 v57, v12, v8, s91
    v_perm_b32 v58, v13, v9, s90
    v_perm_b32 v59, v13, v9, s91
    v_perm_b32 v60, v14, v10, s90
    v_perm_b32 v61, v14, v10, s91
    v_perm_b32 v62, v15, v11, s90
    v_perm_b32 v63, v15, v11, s91
    buffer_load_dwordx4 v[24:27], v3, s[48:51], s9 offen nt
    buffer_load_dwordx4 v[28:31], v3, s[48:51], s9 offen offset:256 nt
    s_add_u32 s9, s9, 32768
    v_dot2c_f32_bf16 v40, v114, v56
    v_dot2c_f32_bf16 v48, v115, v56
    v_dot2c_f32_bf16 v41, v114, v57
    v_dot2c_f32_bf16 v49, v115, v57
    v_dot2c_f32_bf16 v42, v114, v58
    v_dot2c_f32_bf16 v50, v115, v58
    v_dot2c_f32_bf16 v43, v114, v59
    v_dot2c_f32_bf16 v51, v115, v59
    v_dot2c_f32_bf16 v44, v114, v60
    v_dot2c_f32_bf16 v52, v115, v60
    v_dot2c_f32_bf16 v45, v114, v61
    v_dot2c_f32_bf16 v53, v115, v61
    v_dot2c_f32_bf16 v46, v114, v62
    v_dot2c_f32_bf16 v54, v115, v62
    v_dot2c_f32_bf16 v47, v114, v63
    v_dot2c_f32_bf16 v55, v115, v63
    s_barrier
    s_waitcnt vmcnt(2)
    v_perm_b32 v56, v20, v16, s90
    v_perm_b32 v57, v20, v16, s91
    v_perm_b32 v58, v21, v17, s90
    v_perm_b32 v59, v21, v17, s91
    v_perm_b32 v60, v22, v18, s90
    v_perm_b32 v61, v22, v18, s91
    v_perm_b32 v62, v23, v19, s90
    v_perm_b32 v63, v23, v19, s91
    buffer_load_dwordx4 v[32:35], v3, s[48:51], s9 offen nt
    buffer_load_dwordx4 v[36:39], v3, s[48:51], s9 offen offset:256 nt
    s_add_u32 s9, s9, 32768
    v_dot2c_f32_bf16 v40, v116, v56
    v_dot2c_f32_bf16 v48, v117, v56
    v_dot2c_f32_bf16 v41, v116, v57
    v_dot2c_f32_bf16 v49, v117, v57
    v_dot2c_f32_bf16 v42, v116, v58
    v_dot2c_f32_bf16 v50, v117, v58
    v_dot2c_f32_bf16 v43, v116, v59
    v_dot2c_f32_bf16 v51, v117, v59
    v_dot2c_f32_bf16 v44, v116, v60
    v_dot2c_f32_bf16 v52, v117, v60
    v_dot2c_f32_bf16 v45, v116, v61
    v_dot2c_f32_bf16 v53, v117, v61
    v_dot2c_f32_bf16 v46, v116, v62
    v_dot2c_f32_bf16 v54, v117, v62
    v_dot2c_f32_bf16 v47, v116, v63
    v_dot2c_f32_bf16 v55, v117, v63
    s_barrier
    s_waitcnt vmcnt(2)
    v_perm_b32 v56, v28, v24, s90
    v_perm_b32 v57, v28, v24, s91
    v_perm_b32 v58, v29, v25, s90
    v_perm_b32 v59, v29, v25, s91
    v_perm_b32 v60, v30, v26, s90
    v_perm_b32 v61, v30, v26, s91
    v_perm_b32 v62, v31, v27, s90
    v_perm_b32 v63, v31, v27, s91
    buffer_load_dwordx4 v[8:11], v3, s[48:51], s9 offen nt
    buffer_load_dwordx4 v[12:15], v3, s[48:51], s9 offen offset:256 nt
    s_add_u32 s9, s9, 32768
    v_dot2c_f32_bf16 v40, v118, v56
    v_dot2c_f32_bf16 v48, v119, v56
    v_dot2c_f32_bf16 v41, v118, v57
    v_dot2c_f32_bf16 v49, v119, v57
    v_dot2c_f32_bf16 v42, v118, v58
    v_dot2c_f32_bf16 v50, v119, v58
    v_dot2c_f32_bf16 v43, v118, v59
    v_dot2c_f32_bf16 v51, v119, v59
    v_dot2c_f32_bf16 v44, v118, v60
    v_dot2c_f32_bf16 v52, v119, v60
    v_dot2c_f32_bf16 v45, v118, v61
    v_dot2c_f32_bf16 v53, v119, v61
    v_dot2c_f32_bf16 v46, v118, v62
    v_dot2c_f32_bf16 v54, v119, v62
    v_dot2c_f32_bf16 v47, v118, v63
    v_dot2c_f32_bf16 v55, v119, v63
    s_barrier
    s_waitcnt vmcnt(2)
    v_perm_b32 v56, v36, v32, s90
    v_perm_b32 v57, v36, v32, s91
    v_perm_b32 v58, v37, v33, s90
    v_perm_b32 v59, v37, v33, s91
    v_perm_b32 v60, v38, v34, s90
    v_perm_b32 v61, v38, v34, s91
    v_perm_b32 v62, v39, v35, s90
    v_perm_b32 v63, v39, v35, s91
    buffer_load_dwordx4 v[16:19], v3, s[48:51], s9 offen nt
    buffer_load_dwordx4 v[20:23], v3, s[48:51], s9 offen offset:256 nt
    s_add_u32 s9, s9, 32768
    v_dot2c_f32_bf16 v40, v120, v56
    v_dot2c_f32_bf16 v48, v121, v56
    v_dot2c_f32_bf16 v41, v120, v57
    v_dot2c_f32_bf16 v49, v121, v57
    v_dot2c_f32_bf16 v42, v120, v58
    v_dot2c_f32_bf16 v50, v121, v58
    v_dot2c_f32_bf16 v43, v120, v59
    v_dot2c_f32_bf16 v51, v121, v59
    v_dot2c_f32_bf16 v44, v120, v60
    v_dot2c_f32_bf16 v52, v121, v60
    v_dot2c_f32_bf16 v45, v120, v61
    v_dot2c_f32_bf16 v53, v121, v61
    v_dot2c_f32_bf16 v46, v120, v62
    v_dot2c_f32_bf16 v54, v121, v62
    v_dot2c_f32_bf16 v47, v120, v63
    v_dot2c_f32_bf16 v55, v121, v63
    s_barrier
    v_and_b32 v5, 15, v1
    v_lshlrev_b32 v5, 4, v5
    ds_read_b128 v[104:107], v5 offset:17152
    v_mov_b32 v122, v108
    v_mov_b32 v123, v109
    s_waitcnt lgkmcnt(0)
    v_mov_b32 v108, v104
    v_mov_b32 v109, v106
    s_nop 1
    v_max_f32_dpp v108, v108, v108 quad_perm:[1,0,3,2] row_mask:0xf bank_mask:0xf
    v_max_f32_dpp v109, v109, v109 quad_perm:[1,0,3,2] row_mask:0xf bank_mask:0xf
    s_nop 1
    v_max_f32_dpp v108, v108, v108 quad_perm:[2,3,0,1] row_mask:0xf bank_mask:0xf
    v_max_f32_dpp v109, v109, v109 quad_perm:[2,3,0,1] row_mask:0xf bank_mask:0xf
    s_nop 1
    v_max_f32_dpp v108, v108, v108 row_half_mirror row_mask:0xf bank_mask:0xf
    v_max_f32_dpp v109, v109, v109 row_half_mirror row_mask:0xf bank_mask:0xf
    s_nop 1
    v_max_f32_dpp v108, v108, v108 row_mirror row_mask:0xf bank_mask:0xf
    v_max_f32_dpp v109, v109, v109 row_mirror row_mask:0xf bank_mask:0xf
    v_sub_f32 v112, v104, v108
    v_sub_f32 v113, v106, v109
    v_sub_f32 v122, v122, v108
    v_sub_f32 v123, v123, v109
    v_cmp_le_u32 vcc, 32, v1
    v_mul_f32 v112, s95, v112
    v_mul_f32 v113, s95, v113
    v_cndmask_b32 v122, v122, v123, vcc
    v_exp_f32 v112, v112
    v_exp_f32 v113, v113
    v_mul_f32 v122, s95, v122
    v_mul_f32 v110, v112, v105
    v_mul_f32 v111, v113, v107
    v_exp_f32 v122, v122
    s_nop 1
    v_add_f32_dpp v110, v110, v110 quad_perm:[1,0,3,2] row_mask:0xf bank_mask:0xf
    v_add_f32_dpp v111, v111, v111 quad_perm:[1,0,3,2] row_mask:0xf bank_mask:0xf
    s_nop 1
    v_add_f32_dpp v110, v110, v110 quad_perm:[2,3,0,1] row_mask:0xf bank_mask:0xf
    v_add_f32_dpp v111, v111, v111 quad_perm:[2,3,0,1] row_mask:0xf bank_mask:0xf
    s_nop 1
    v_add_f32_dpp v110, v110, v110 row_half_mirror row_mask:0xf bank_mask:0xf
    v_add_f32_dpp v111, v111, v111 row_half_mirror row_mask:0xf bank_mask:0xf
    s_nop 1
    v_add_f32_dpp v110, v110, v110 row_mirror row_mask:0xf bank_mask:0xf
    v_add_f32_dpp v111, v111, v111 row_mirror row_mask:0xf bank_mask:0xf
    s_cmp_lg_u32 s3, 9
    s_cbranch_scc1 L_nostat
    v_mov_b32 v104, v108
    v_mov_b32 v105, v110
    v_mov_b32 v106, v109
    v_mov_b32 v107, v111
    v_min_u32 v104, -2, v104
    v_min_u32 v105, -2, v105
    v_min_u32 v106, -2, v106
    v_min_u32 v107, -2, v107
    s_mov_b64 exec, 1
    buffer_store_dwordx4 v[104:107], v124, s[60:63], 0 offen sc1
    s_mov_b64 exec, -1
L_nostat:
    s_lshl_b32 s12, s4, 2
    v_mov_b32 v5, s12
    buffer_load_dword v123, v5, s[64:67], 0 offen offset:192 sc1
    ds_read_b64 v[114:115], v4 offset:384
    ds_read_b64 v[116:117], v4 offset:416
    ds_read_b64 v[118:119], v4 offset:448
    ds_read_b64 v[120:121], v4 offset:480
    s_waitcnt vmcnt(2) lgkmcnt(0)
    v_perm_b32 v56, v12, v8, s90
    v_perm_b32 v57, v12, v8, s91
    v_perm_b32 v58, v13, v9, s90
    v_perm_b32 v59, v13, v9, s91
    v_perm_b32 v60, v14, v10, s90
    v_perm_b32 v61, v14, v10, s91
    v_perm_b32 v62, v15, v11, s90
    v_perm_b32 v63, v15, v11, s91
    buffer_load_dwordx4 v[24:27], v3, s[48:51], s9 offen nt
    buffer_load_dwordx4 v[28:31], v3, s[48:51], s9 offen offset:256 nt
    s_add_u32 s9, s9, 32768
    v_dot2c_f32_bf16 v40, v114, v56
    v_dot2c_f32_bf16 v48, v115, v56
    v_dot2c_f32_bf16 v41, v114, v57
    v_dot2c_f32_bf16 v49, v115, v57
    v_dot2c_f32_bf16 v42, v114, v58
    v_dot2c_f32_bf16 v50, v115, v58
    v_dot2c_f32_bf16 v43, v114, v59
    v_dot2c_f32_bf16 v51, v115, v59
    v_dot2c_f32_bf16 v44, v114, v60
    v_dot2c_f32_bf16 v52, v115, v60
    v_dot2c_f32_bf16 v45, v114, v61
    v_dot2c_f32_bf16 v53, v115, v61
    v_dot2c_f32_bf16 v46, v114, v62
    v_dot2c_f32_bf16 v54, v115, v62
    v_dot2c_f32_bf16 v47, v114, v63
    v_dot2c_f32_bf16 v55, v115, v63
    s_barrier
    s_waitcnt vmcnt(2)
    v_perm_b32 v56, v20, v16, s90
    v_perm_b32 v57, v20, v16, s91
    v_perm_b32 v58, v21, v17, s90
    v_perm_b32 v59, v21, v17, s91
    v_perm_b32 v60, v22, v18, s90
    v_perm_b32 v61, v22, v18, s91
    v_perm_b32 v62, v23, v19, s90
    v_perm_b32 v63, v23, v19, s91
    buffer_load_dwordx4 v[32:35], v3, s[48:51], s9 offen nt
    buffer_load_dwordx4 v[36:39], v3, s[48:51], s9 offen offset:256 nt
    s_add_u32 s9, s9, 32768
    v_dot2c_f32_bf16 v40, v116, v56
    v_dot2c_f32_bf16 v48, v117, v56
    v_dot2c_f32_bf16 v41, v116, v57
    v_dot2c_f32_bf16 v49, v117, v57
    v_dot2c_f32_bf16 v42, v116, v58
    v_dot2c_f32_bf16 v50, v117, v58
    v_dot2c_f32_bf16 v43, v116, v59
    v_dot2c_f32_bf16 v51, v117, v59
    v_dot2c_f32_bf16 v44, v116, v60
    v_dot2c_f32_bf16 v52, v117, v60
    v_dot2c_f32_bf16 v45, v116, v61
    v_dot2c_f32_bf16 v53, v117, v61
    v_dot2c_f32_bf16 v46, v116, v62
    v_dot2c_f32_bf16 v54, v117, v62
    v_dot2c_f32_bf16 v47, v116, v63
    v_dot2c_f32_bf16 v55, v117, v63
    s_barrier
    s_waitcnt vmcnt(2)
    v_perm_b32 v56, v28, v24, s90
    v_perm_b32 v57, v28, v24, s91
    v_perm_b32 v58, v29, v25, s90
    v_perm_b32 v59, v29, v25, s91
    v_perm_b32 v60, v30, v26, s90
    v_perm_b32 v61, v30, v26, s91
    v_perm_b32 v62, v31, v27, s90
    v_perm_b32 v63, v31, v27, s91
    v_dot2c_f32_bf16 v40, v118, v56
    v_dot2c_f32_bf16 v48, v119, v56
    v_dot2c_f32_bf16 v41, v118, v57
    v_dot2c_f32_bf16 v49, v119, v57
    v_dot2c_f32_bf16 v42, v118, v58
    v_dot2c_f32_bf16 v50, v119, v58
    v_dot2c_f32_bf16 v43, v118, v59
    v_dot2c_f32_bf16 v51, v119, v59
    v_dot2c_f32_bf16 v44, v118, v60
    v_dot2c_f32_bf16 v52, v119, v60
    v_dot2c_f32_bf16 v45, v118, v61
    v_dot2c_f32_bf16 v53, v119, v61
    v_dot2c_f32_bf16 v46, v118, v62
    v_dot2c_f32_bf16 v54, v119, v62
    v_dot2c_f32_bf16 v47, v118, v63
    v_dot2c_f32_bf16 v55, v119, v63
    s_barrier
    s_waitcnt vmcnt(0)
    v_perm_b32 v56, v36, v32, s90
    v_perm_b32 v57, v36, v32, s91
    v_perm_b32 v58, v37, v33, s90
    v_perm_b32 v59, v37, v33, s91
    v_perm_b32 v60, v38, v34, s90
    v_perm_b32 v61, v38, v34, s91
    v_perm_b32 v62, v39, v35, s90
    v_perm_b32 v63, v39, v35, s91
    v_dot2c_f32_bf16 v40, v120, v56
    v_dot2c_f32_bf16 v48, v121, v56
    v_dot2c_f32_bf16 v41, v120, v57
    v_dot2c_f32_bf16 v49, v121, v57
    v_dot2c_f32_bf16 v42, v120, v58
    v_dot2c_f32_bf16 v50, v121, v58
    v_dot2c_f32_bf16 v43, v120, v59
    v_dot2c_f32_bf16 v51, v121, v59
    v_dot2c_f32_bf16 v44, v120, v60
    v_dot2c_f32_bf16 v52, v121, v60
    v_dot2c_f32_bf16 v45, v120, v61
    v_dot2c_f32_bf16 v53, v121, v61
    v_dot2c_f32_bf16 v46, v120, v62
    v_dot2c_f32_bf16 v54, v121, v62
    v_dot2c_f32_bf16 v47, v120, v63
    v_dot2c_f32_bf16 v55, v121, v63
    s_nop 3
    v_permlane32_swap_b32 v40, v48
    v_permlane32_swap_b32 v41, v49
    v_permlane32_swap_b32 v42, v50
    v_permlane32_swap_b32 v43, v51
    v_permlane32_swap_b32 v44, v52
    v_permlane32_swap_b32 v45, v53
    v_permlane32_swap_b32 v46, v54
    v_permlane32_swap_b32 v47, v55
    v_lshrrev_b32 v5, 5, v1
    v_lshlrev_b32 v5, 9, v5
    v_add_f32 v40, v40, v48
    v_add_f32 v41, v41, v49
    v_add_f32 v42, v42, v50
    v_add_f32 v43, v43, v51
    v_add_f32 v44, v44, v52
    v_add_f32 v45, v45, v53
    v_add_f32 v46, v46, v54
    v_add_f32 v47, v47, v55
    v_and_b32 v6, 15, v1
    v_lshl_add_u32 v5, v6, 5, v5
    v_permlane16_swap_b32 v40, v44
    v_permlane16_swap_b32 v41, v45
    v_permlane16_swap_b32 v42, v46
    v_permlane16_swap_b32 v43, v47
    v_and_b32 v6, 16, v1
    v_add_u32 v5, v6, v5
    v_add_f32 v40, v40, v44
    v_add_f32 v41, v41, v45
    v_add_f32 v42, v42, v46
    v_add_f32 v43, v43, v47
    v_add_u32 v5, s76, v5
    s_nop 0
    v_mul_f32 v40, v40, v122
    v_mul_f32 v41, v41, v122
    v_mul_f32 v42, v42, v122
    v_mul_f32 v43, v43, v122
    ds_write_b128 v5, v[40:43] offset:0
    v_lshrrev_b32 v5, 2, v1
    v_mul_u32_u24 v6, 1040, v5
    v_and_b32 v7, 3, v1
    v_lshl_add_u32 v6, v7, 4, v6
    s_lshl_b32 s12, s3, 6
    v_add_u32 v6, s12, v6
    s_lshl_b32 s12, s4, 2
    v_mov_b32 v5, s12
    s_mov_b32 s96, 0
L_fpoll:
    v_cmp_gt_u32 vcc, 0x80, v123
    s_nop 3
    s_cmp_eq_u64 vcc, 0
    s_cbranch_scc1 L_fgot
    s_add_u32 s96, s96, 1
    s_cmp_ge_u32 s96, 400000
    s_cbranch_scc1 L_fgot
    buffer_load_dword v123, v5, s[64:67], 0 offen offset:192 sc1
    s_waitcnt vmcnt(0)
    s_branch L_fpoll
L_fgot:
    s_lshl_b32 s12, s4, 7
    s_lshl_b32 s13, s5, 3
    s_add_u32 s12, s12, s13
    s_lshl_b32 s12, s12, 4
    v_lshrrev_b32 v5, 3, v1
    v_lshl_add_u32 v2, v5, 4, s12
    s_cmp_lg_u32 s3, 15
    s_cbranch_scc1 L_nost
    buffer_load_dwordx4 v[104:107], v2, s[60:63], 0 offen offset:0 sc1
L_nost:
    s_lshl_b32 s12, s8, 13
    s_lshl_b32 s13, s6, 7
    s_add_u32 s12, s12, s13
    s_add_u32 s12, s12, 36864
    v_lshl_add_u32 v5, v5, 10, s12
    v_and_b32 v7, 7, v1
    v_lshl_add_u32 v5, v7, 4, v5
    s_waitcnt lgkmcnt(0)
    s_barrier
    ds_read_b128 v[56:59], v6 offset:0
    s_waitcnt lgkmcnt(0)
    v_add_f32_dpp v56, v56, v56 row_ror:4 row_mask:0xf bank_mask:0xf
    v_add_f32_dpp v57, v57, v57 row_ror:4 row_mask:0xf bank_mask:0xf
    v_add_f32_dpp v58, v58, v58 row_ror:4 row_mask:0xf bank_mask:0xf
    v_add_f32_dpp v59, v59, v59 row_ror:4 row_mask:0xf bank_mask:0xf
    s_nop 0
    v_add_f32_dpp v56, v56, v56 row_ror:8 row_mask:0xf bank_mask:0xf
    v_add_f32_dpp v57, v57, v57 row_ror:8 row_mask:0xf bank_mask:0xf
    v_add_f32_dpp v58, v58, v58 row_ror:8 row_mask:0xf bank_mask:0xf
    v_add_f32_dpp v59, v59, v59 row_ror:8 row_mask:0xf bank_mask:0xf
    s_nop 0
    v_mov_b32 v60, v56
    v_mov_b32 v61, v57
    v_mov_b32 v62, v58
    v_mov_b32 v63, v59
    s_nop 1
    v_permlane16_swap_b32 v56, v60
    v_permlane16_swap_b32 v57, v61
    v_permlane16_swap_b32 v58, v62
    v_permlane16_swap_b32 v59, v63
    s_nop 1
    v_add_f32 v56, v56, v60
    v_add_f32 v57, v57, v61
    v_add_f32 v58, v58, v62
    v_add_f32 v59, v59, v63
    v_mov_b32 v60, v56
    v_mov_b32 v61, v57
    v_mov_b32 v62, v58
    v_mov_b32 v63, v59
    s_nop 1
    v_permlane32_swap_b32 v56, v60
    v_permlane32_swap_b32 v57, v61
    v_permlane32_swap_b32 v58, v62
    v_permlane32_swap_b32 v59, v63
    s_nop 1
    v_add_f32 v56, v56, v60
    v_add_f32 v57, v57, v61
    v_add_f32 v58, v58, v62
    v_add_f32 v59, v59, v63
    v_min_u32 v56, -2, v56
    v_min_u32 v57, -2, v57
    v_min_u32 v58, -2, v58
    v_min_u32 v59, -2, v59
    s_mov_b64 exec, 0xf
    buffer_store_dwordx4 v[56:59], v127, s[60:63], 0 offen sc1
    s_mov_b64 exec, -1
    s_cmp_lg_u32 s3, 15
    s_cbranch_scc1 L_nopoll
    buffer_load_dwordx4 v[8:11], v5, s[60:63], 0 offen sc1
    s_mov_b32 s96, 0
    s_waitcnt vmcnt(2)
    v_max3_u32 v60, v104, v105, v106
    v_max_u32 v60, v60, v107
    v_cmp_eq_u32 vcc, -1, v60
    s_add_u32 s96, s96, 1
    s_nop 2
    s_cmp_eq_u64 vcc, 0
    s_cbranch_scc1 L_sgot
L_spoll:
    buffer_load_dwordx4 v[104:107], v2, s[60:63], 0 offen offset:0 sc1
    s_waitcnt vmcnt(0)
    v_max3_u32 v60, v104, v105, v106
    v_max_u32 v60, v60, v107
    v_cmp_eq_u32 vcc, -1, v60
    s_add_u32 s96, s96, 1
    s_nop 2
    s_cmp_eq_u64 vcc, 0
    s_cbranch_scc1 L_sgot
    s_cmp_lt_u32 s96, 400000
    s_cbranch_scc1 L_spoll
L_sgot:
    s_cmp_ge_u32 s6, 4
    s_cselect_b64 vcc, -1, 0
    v_cndmask_b32 v112, v104, v106, vcc
    v_cndmask_b32 v113, v105, v107, vcc
    s_nop 1
    v_max_f32_dpp v108, v112, v112 row_ror:8 row_mask:0xf bank_mask:0xf
    v_mov_b32 v109, v108
    s_nop 1
    v_permlane16_swap_b32 v108, v109
    s_nop 1
    v_max_f32 v108, v108, v109
    v_mov_b32 v109, v108
    s_nop 1
    v_permlane32_swap_b32 v108, v109
    s_nop 1
    v_max_f32 v108, v108, v109
    v_sub_f32 v112, v112, v108
    v_mul_f32 v112, s95, v112
    v_exp_f32 v112, v112
    s_nop 0
    v_mul_f32 v110, v112, v113
    s_nop 1
    v_add_f32_dpp v110, v110, v110 row_ror:8 row_mask:0xf bank_mask:0xf
    v_mov_b32 v109, v110
    s_nop 1
    v_permlane16_swap_b32 v110, v109
    s_nop 1
    v_add_f32 v110, v110, v109
    v_mov_b32 v109, v110
    s_nop 1
    v_permlane32_swap_b32 v110, v109
    s_nop 1
    v_add_f32 v110, v110, v109
    v_rcp_f32 v110, v110
    v_lshlrev_b32 v6, 3, v1
    v_mul_f32 v112, v112, v110
L_opoll:
    buffer_load_dwordx4 v[12:15], v5, s[60:63], 0 offen sc1
    s_waitcnt vmcnt(1)
    v_max3_u32 v60, v8, v9, v10
    v_max_u32 v60, v60, v11
    v_cmp_eq_u32 vcc, -1, v60
    s_add_u32 s96, s96, 1
    s_nop 2
    s_cmp_eq_u64 vcc, 0
    s_cbranch_scc1 L_ogot
    buffer_load_dwordx4 v[8:11], v5, s[60:63], 0 offen sc1
    s_waitcnt vmcnt(1)
    v_max3_u32 v60, v12, v13, v14
    v_max_u32 v60, v60, v15
    v_cmp_eq_u32 vcc, -1, v60
    s_add_u32 s96, s96, 1
    s_nop 2
    s_cmp_eq_u64 vcc, 0
    s_cbranch_scc1 L_ogot2
    s_cmp_lt_u32 s96, 400000
    s_cbranch_scc1 L_opoll
L_ogot2:
    v_mul_f32 v56, v12, v112
    v_mul_f32 v57, v13, v112
    v_mul_f32 v58, v14, v112
    v_mul_f32 v59, v15, v112
    s_branch L_ojoin
L_ogot:
    v_mul_f32 v56, v8, v112
    v_mul_f32 v57, v9, v112
    v_mul_f32 v58, v10, v112
    v_mul_f32 v59, v11, v112
L_ojoin:
    s_nop 0
    v_add_f32_dpp v56, v56, v56 row_ror:8 row_mask:0xf bank_mask:0xf
    v_add_f32_dpp v57, v57, v57 row_ror:8 row_mask:0xf bank_mask:0xf
    v_add_f32_dpp v58, v58, v58 row_ror:8 row_mask:0xf bank_mask:0xf
    v_add_f32_dpp v59, v59, v59 row_ror:8 row_mask:0xf bank_mask:0xf
    v_mov_b32 v60, v56
    v_mov_b32 v61, v57
    v_mov_b32 v62, v58
    v_mov_b32 v63, v59
    s_nop 1
    v_permlane16_swap_b32 v56, v60
    v_permlane16_swap_b32 v57, v61
    v_permlane16_swap_b32 v58, v62
    v_permlane16_swap_b32 v59, v63
    s_nop 1
    v_add_f32 v56, v56, v60
    v_add_f32 v57, v57, v61
    v_add_f32 v58, v58, v62
    v_add_f32 v59, v59, v63
    v_mov_b32 v60, v56
    v_mov_b32 v61, v57
    v_mov_b32 v62, v58
    v_mov_b32 v63, v59
    s_nop 1
    v_permlane32_swap_b32 v56, v60
    v_permlane32_swap_b32 v57, v61
    v_permlane32_swap_b32 v58, v62
    v_permlane32_swap_b32 v59, v63
    s_nop 1
    v_add_f32 v56, v56, v60
    v_add_f32 v57, v57, v61
    v_add_f32 v58, v58, v62
    v_add_f32 v59, v59, v63
    v_cvt_pk_bf16_f32 v56, v56, v57
    v_cvt_pk_bf16_f32 v57, v58, v59
    s_mov_b64 exec, 0xff
    ds_write_b64 v6, v[56:57] offset:16640
    s_mov_b64 exec, -1
    s_waitcnt lgkmcnt(0)
L_nopoll:
    v_lshrrev_b32 v6, 5, v1
    s_lshl_b32 s12, s3, 3
    v_lshl_add_u32 v6, v6, 2, s12
    v_mov_b32 v40, 0
    v_mov_b32 v41, 0
    v_mov_b32 v42, 0
    v_mov_b32 v43, 0
    v_mov_b32 v44, 0
    v_mov_b32 v45, 0
    v_mov_b32 v46, 0
    v_mov_b32 v47, 0
    v_mov_b32 v48, 0
    v_mov_b32 v49, 0
    v_mov_b32 v50, 0
    v_mov_b32 v51, 0
    v_mov_b32 v52, 0
    v_mov_b32 v53, 0
    v_mov_b32 v54, 0
    v_mov_b32 v55, 0
    v_mov_b32 v114, 0
    v_mov_b32 v115, 0
    s_barrier
    s_cmp_ge_u32 s3, 8
    s_cbranch_scc1 L_nogemv
    ds_read_b32 v56, v6 offset:16640
    s_waitcnt lgkmcnt(0)
    v_dot2c_f32_bf16 v40, v56, v64
    v_dot2c_f32_bf16 v41, v56, v72
    v_dot2c_f32_bf16 v42, v56, v65
    v_dot2c_f32_bf16 v43, v56, v73
    v_dot2c_f32_bf16 v44, v56, v66
    v_dot2c_f32_bf16 v45, v56, v74
    v_dot2c_f32_bf16 v46, v56, v67
    v_dot2c_f32_bf16 v47, v56, v75
    v_dot2c_f32_bf16 v48, v56, v68
    v_dot2c_f32_bf16 v49, v56, v76
    v_dot2c_f32_bf16 v50, v56, v69
    v_dot2c_f32_bf16 v51, v56, v77
    v_dot2c_f32_bf16 v52, v56, v70
    v_dot2c_f32_bf16 v53, v56, v78
    v_dot2c_f32_bf16 v54, v56, v71
    v_dot2c_f32_bf16 v55, v56, v79
    v_dot2c_f32_bf16 v114, v56, v80
    v_dot2c_f32_bf16 v115, v56, v81
    s_mul_i32 s12, s3, 2304
    v_and_b32 v5, 31, v1
    v_lshrrev_b32 v6, 5, v1
    v_lshl_add_u32 v7, v5, 1, v6
    v_lshl_add_u32 v5, v7, 4, s12
    v_lshl_add_u32 v7, v7, 2, s12
    v_permlane32_swap_b32 v40, v44
    v_permlane32_swap_b32 v41, v45
    v_permlane32_swap_b32 v42, v46
    v_permlane32_swap_b32 v43, v47
    v_permlane32_swap_b32 v48, v52
    v_permlane32_swap_b32 v49, v53
    v_permlane32_swap_b32 v50, v54
    v_permlane32_swap_b32 v51, v55
    v_permlane32_swap_b32 v114, v115
    s_nop 1
    v_add_f32 v40, v40, v44
    v_add_f32 v41, v41, v45
    v_add_f32 v42, v42, v46
    v_add_f32 v43, v43, v47
    v_add_f32 v48, v48, v52
    v_add_f32 v49, v49, v53
    v_add_f32 v50, v50, v54
    v_add_f32 v51, v51, v55
    v_add_f32 v114, v114, v115
    ds_write_b128 v5, v[40:43] offset:17424
    ds_write_b128 v5, v[48:51] offset:18448
    ds_write_b32 v7, v114 offset:19472
L_nogemv:
    v_and_b32 v5, 15, v1
    s_lshl_b32 s12, s3, 4
    v_add_u32 v5, s12, v5
    v_lshrrev_b32 v6, 4, v1
    v_mul_u32_u24 v6, 4608, v6
    v_lshl_add_u32 v5, v5, 4, v6
    s_waitcnt lgkmcnt(0)
    s_barrier
    s_cmp_ge_u32 s3, 9
    s_cbranch_scc1 L_ydone
    ds_read_b128 v[40:43], v5 offset:17424
    ds_read_b128 v[44:47], v5 offset:19728
    s_waitcnt lgkmcnt(0)
    v_add_f32 v40, v40, v44
    v_add_f32 v41, v41, v45
    v_add_f32 v42, v42, v46
    v_add_f32 v43, v43, v47
    v_mov_b32 v44, v40
    v_mov_b32 v45, v41
    v_mov_b32 v46, v42
    v_mov_b32 v47, v43
    s_nop 1
    v_permlane16_swap_b32 v40, v44
    v_permlane16_swap_b32 v41, v45
    v_permlane16_swap_b32 v42, v46
    v_permlane16_swap_b32 v43, v47
    s_nop 1
    v_add_f32 v40, v40, v44
    v_add_f32 v41, v41, v45
    v_add_f32 v42, v42, v46
    v_add_f32 v43, v43, v47
    v_mov_b32 v44, v40
    v_mov_b32 v45, v41
    v_mov_b32 v46, v42
    v_mov_b32 v47, v43
    s_nop 1
    v_permlane32_swap_b32 v40, v44
    v_permlane32_swap_b32 v41, v45
    v_permlane32_swap_b32 v42, v46
    v_permlane32_swap_b32 v43, v47
    s_nop 1
    v_add_f32 v40, v40, v44
    v_add_f32 v41, v41, v45
    v_add_f32 v42, v42, v46
    v_add_f32 v43, v43, v47
    v_min_u32 v40, -2, v40
    v_min_u32 v41, -2, v41
    v_min_u32 v42, -2, v42
    v_min_u32 v43, -2, v43
    s_mov_b64 exec, 0xffff
    buffer_store_dwordx4 v[40:43], v124, s[60:63], 0 offen sc1
    s_mov_b64 exec, -1
    s_nop 1
L_ydone:
    s_cmp_ge_u32 s7, 18
    s_cbranch_scc1 L_end
    s_mul_i32 s12, s4, 294912
    s_lshl_b32 s13, s7, 14
    s_add_u32 s12, s12, s13
    s_add_u32 s12, s12, 299008
    v_lshl_add_u32 v5, v0, 4, s12
    s_mov_b32 s96, 0
    buffer_load_dwordx4 v[16:19], v5, s[60:63], 0 offen sc1
L_cpoll:
    buffer_load_dwordx4 v[20:23], v5, s[60:63], 0 offen sc1
    s_waitcnt vmcnt(1)
    v_max3_u32 v60, v16, v17, v18
    v_max_u32 v60, v60, v19
    v_cmp_eq_u32 vcc, -1, v60
    s_add_u32 s96, s96, 1
    s_nop 2
    s_cmp_eq_u64 vcc, 0
    s_cbranch_scc1 L_cgot
    buffer_load_dwordx4 v[16:19], v5, s[60:63], 0 offen sc1
    s_waitcnt vmcnt(1)
    v_max3_u32 v60, v20, v21, v22
    v_max_u32 v60, v60, v23
    v_cmp_eq_u32 vcc, -1, v60
    s_add_u32 s96, s96, 1
    s_nop 2
    s_cmp_eq_u64 vcc, 0
    s_cbranch_scc1 L_cgot2
    s_cmp_lt_u32 s96, 400000
    s_cbranch_scc1 L_cpoll
L_cgot2:
    v_add_f32_dpp v56, v20, v20 row_ror:8 row_mask:0xf bank_mask:0xf
    v_add_f32_dpp v57, v21, v21 row_ror:8 row_mask:0xf bank_mask:0xf
    v_add_f32_dpp v58, v22, v22 row_ror:8 row_mask:0xf bank_mask:0xf
    v_add_f32_dpp v59, v23, v23 row_ror:8 row_mask:0xf bank_mask:0xf
    s_branch L_cjoin
L_cgot:
    v_add_f32_dpp v56, v16, v16 row_ror:8 row_mask:0xf bank_mask:0xf
    v_add_f32_dpp v57, v17, v17 row_ror:8 row_mask:0xf bank_mask:0xf
    v_add_f32_dpp v58, v18, v18 row_ror:8 row_mask:0xf bank_mask:0xf
    v_add_f32_dpp v59, v19, v19 row_ror:8 row_mask:0xf bank_mask:0xf
L_cjoin:
    v_mov_b32 v60, v56
    v_mov_b32 v61, v57
    v_mov_b32 v62, v58
    v_mov_b32 v63, v59
    s_nop 1
    v_permlane16_swap_b32 v56, v60
    v_permlane16_swap_b32 v57, v61
    v_permlane16_swap_b32 v58, v62
    v_permlane16_swap_b32 v59, v63
    s_nop 1
    v_add_f32 v56, v56, v60
    v_add_f32 v57, v57, v61
    v_add_f32 v58, v58, v62
    v_add_f32 v59, v59, v63
    v_mov_b32 v60, v56
    v_mov_b32 v61, v57
    v_mov_b32 v62, v58
    v_mov_b32 v63, v59
    s_nop 1
    v_permlane32_swap_b32 v56, v60
    v_permlane32_swap_b32 v57, v61
    v_permlane32_swap_b32 v58, v62
    v_permlane32_swap_b32 v59, v63
    s_nop 1
    v_add_f32 v56, v56, v60
    v_add_f32 v57, v57, v61
    v_add_f32 v58, v58, v62
    v_add_f32 v59, v59, v63
    s_lshl_b32 s12, s3, 7
    v_lshl_add_u32 v5, v1, 4, s12
    s_mov_b64 exec, 0xff
    ds_write_b128 v5, v[56:59] offset:0
    s_mov_b64 exec, -1
    s_waitcnt lgkmcnt(0)
    s_barrier
    s_cmp_lg_u32 s3, 0
    s_cbranch_scc1 L_end
    v_and_b32 v5, 31, v1
    v_lshlrev_b32 v6, 2, v5
    ds_read_b32 v64, v6 offset:0
    ds_read_b32 v65, v6 offset:128
    ds_read_b32 v66, v6 offset:256
    ds_read_b32 v67, v6 offset:384
    ds_read_b32 v68, v6 offset:512
    ds_read_b32 v69, v6 offset:640
    ds_read_b32 v70, v6 offset:768
    ds_read_b32 v71, v6 offset:896
    ds_read_b32 v72, v6 offset:1024
    ds_read_b32 v73, v6 offset:1152
    ds_read_b32 v74, v6 offset:1280
    ds_read_b32 v75, v6 offset:1408
    ds_read_b32 v76, v6 offset:1536
    ds_read_b32 v77, v6 offset:1664
    ds_read_b32 v78, v6 offset:1792
    ds_read_b32 v79, v6 offset:1920
    s_mul_i32 s12, s4, 1152
    s_lshl_b32 s13, s7, 6
    s_add_u32 s12, s12, s13
    v_lshl_add_u32 v5, v5, 1, s12
    s_waitcnt lgkmcnt(0)
    v_add_f32 v64, v64, v72
    v_add_f32 v65, v65, v73
    v_add_f32 v66, v66, v74
    v_add_f32 v67, v67, v75
    v_add_f32 v68, v68, v76
    v_add_f32 v69, v69, v77
    v_add_f32 v70, v70, v78
    v_add_f32 v71, v71, v79
    v_add_f32 v64, v64, v68
    v_add_f32 v65, v65, v69
    v_add_f32 v66, v66, v70
    v_add_f32 v67, v67, v71
    v_add_f32 v64, v64, v66
    v_add_f32 v65, v65, v67
    v_add_f32 v64, v64, v65
    v_cvt_pk_bf16_f32 v64, v64, v64
    s_mov_b32 exec_hi, 0
    buffer_store_short v64, v5, s[68:71], 0 offen
    s_mov_b32 exec_hi, -1
L_end:
    s_endpgm
L_codeend:
.section .rodata,"a"
.p2align 6
.amdhsa_kernel concat_heads__gqa_block_cached__gqa_block_cached__decode_kernel
  .amdhsa_next_free_vgpr 128
  .amdhsa_next_free_sgpr 102
  .amdhsa_accum_offset 128
  .amdhsa_group_segment_fixed_size 0
  .amdhsa_kernarg_size 104
  .amdhsa_user_sgpr_count 2
  .amdhsa_user_sgpr_kernarg_segment_ptr 1
  .amdhsa_system_sgpr_workgroup_id_x 1
.end_amdhsa_kernel
```
